```python
import torch

def _softmax(x, axis=-1):
    return torch.softmax(x, dim=axis)
def _gelu(x):
    return torch.nn.functional.gelu(x, approximate="tanh")
def _silu(x):
    return torch.nn.functional.silu(x)
def _sigmoid(x):
    return torch.sigmoid(x)
def _layernorm(x, axis=-1, eps=1e-5):
    m = x.mean(dim=axis, keepdim=True)
    v = x.var(dim=axis, keepdim=True, unbiased=False)
    return (x - m) / torch.sqrt(v + eps)
def _scatter_add(tgt, idx, src, axis=0):
    return tgt.clone().index_add_(axis, idx, src)
def _segment_sum(src, seg, n):
    out = torch.zeros((n,) + src.shape[1:], dtype=src.dtype)
    return out.index_add_(0, seg, src)
def _pad(x, pw):
    flat = tuple(v for pair in reversed(pw) for v in pair)
    return torch.nn.functional.pad(x, flat)

kernel_name = 'standalone__standard_2d_1d_3d_conv__vision'

def setup_inputs():

    _w = (lambda a: (lambda t: t.to(torch.bfloat16) if t.is_floating_point() else t)(torch.as_tensor(a)))
    H = W = 384
    C = 96
    K = 3
    return {
        "x": _w((lambda *s: torch.randn(*s, dtype=torch.bfloat16) * 0.05)(1, H, W, C)),
        "w": _w((lambda *s: torch.randn(*s, dtype=torch.bfloat16) * 0.05)(K, K, C, C)),
        "b": _w((lambda *s: torch.randn(*s, dtype=torch.bfloat16) * 0.05)(C)),
    }

def reference(x, w, b):
    B, H, W, Cin = x.shape
    K = w.shape[0]
    pl = (K - 1) // 2
    pr = K // 2
    xp = _pad(x, ((0, 0), (pl, pr), (pl, pr), (0, 0)))
    out = sum(
        torch.einsum('bhwc,cd->bhwd', xp[:, i:i+H, j:j+W, :], w[i, j])
        for i in range(K) for j in range(K)
    )
    return out + b[None, None, None, :]
```

```asm
; @launch grid=(256,1,1) block=(256,1,1) lds=163840
.amdgcn_target "amdgcn-amd-amdhsa--gfx950"
.text
.set CODE_TOUCH_MAX, 19968
.globl standalone__standard_2d_1d_3d_conv__vision_kernel
.p2align 12
.p2align 8
.type standalone__standard_2d_1d_3d_conv__vision_kernel,@function
standalone__standard_2d_1d_3d_conv__vision_kernel:
s_load_dwordx8 s[4:11], s[0:1], 0
s_cmp_ge_u32 s2, 256
s_cbranch_scc1 Lend
s_getpc_b64 s[54:55]
s_lshr_b32 s3, s2, 3
s_lshl_b32 s3, s3, 10
s_min_u32 s3, s3, CODE_TOUCH_MAX
v_lshrrev_b32 v33, 5, v0
v_lshl_add_u32 v34, v33, 7, s3
v_mov_b32 v35, s55
v_add_co_u32 v34, vcc, s54, v34
s_nop 1
v_addc_co_u32 v35, vcc, 0, v35, vcc
global_load_dword v18, v[34:35], off
v_lshrrev_b32 v32, 6, v0
v_and_b32 v0, 63, v0
v_readfirstlane_b32 s28, v32
s_lshr_b32 s35, s2, 3
s_lshl_b32 s45, s35, 2
v_lshlrev_b32 v176, 4, v0
v_and_b32 v35, 32, v0
s_mul_i32 s47, s28, 3072
s_add_u32 s45, s45, s28
v_xor_b32 v177, v176, v35
v_xor_b32 v178, 32, v176
s_mul_i32 s45, s45, 1408
s_min_u32 s45, s45, 164480
v_min_u32 v37, 10, v0
v_lshlrev_b32 v37, 7, v37
s_mov_b32 s18, 165888
s_mov_b32 s19, 0x00020000
s_and_b32 s34, s2, 7
s_lshr_b32 s35, s2, 3
s_and_b32 s32, s35, 7
s_lshr_b32 s35, s35, 3
s_lshl_b32 s34, s34, 2
s_add_u32 s31, s34, s35
s_mul_i32 s33, s31, 12
s_and_b32 s29, s28, 1
s_lshr_b32 s30, s28, 1
s_mul_i32 s44, s32, 9216
s_lshl_b32 s34, s29, 6
v_add_u32 v32, s34, v0
s_mov_b32 s35, 43691
v_mul_u32_u24 v33, s35, v32
s_sub_u32 s34, s44, 192
v_lshl_add_u32 v32, v32, 4, s34
s_mul_i32 s34, s29, 40
v_lshrrev_b32 v34, 16, v33
v_and_b32 v34, 32, v34
v_xor_b32 v4, v32, v34
v_add_u32 v34, 5592448, v33
v_lshrrev_b32 v34, 16, v34
v_and_b32 v34, 32, v34
v_add_u32 v35, 2048, v32
v_xor_b32 v5, v35, v34
v_add_u32 v34, 11184896, v33
v_lshrrev_b32 v34, 16, v34
v_and_b32 v34, 32, v34
v_add_u32 v35, 4096, v32
v_xor_b32 v6, v35, v34
v_add_u32 v34, 16777344, v33
v_lshrrev_b32 v34, 16, v34
v_and_b32 v34, 32, v34
v_add_u32 v35, 6144, v32
v_xor_b32 v7, v35, v34
s_sub_u32 s34, 512, s34
s_mul_i32 s35, s34, 43691
s_lshl_b32 s34, s34, 4
v_add_u32 v34, s35, v33
v_lshrrev_b32 v34, 16, v34
v_and_b32 v34, 32, v34
v_add_u32 v35, s34, v32
v_xor_b32 v8, v35, v34
v_mov_b32 v46, 0x7fffff00
s_mov_b32 s35, 73728
v_cmp_gt_u32 vcc, s35, v4
v_cmp_gt_u32 s[34:35], s35, v8
v_and_b32 v36, 15, v0
v_cndmask_b32 v4, v46, v4, vcc
v_cndmask_b32 v8, v46, v8, s[34:35]
s_add_u32 s34, s33, s30
s_add_u32 s34, s34, 5
s_mul_i32 s40, s34, 73728
s_mul_i32 s42, s30, 9600
s_mul_i32 s35, s29, 384
s_add_u32 s43, s42, s35
s_lshl_b32 s35, s29, 10
s_add_u32 s42, s42, s35
s_lshl_b32 s34, s29, 7
s_lshl_b32 s35, s29, 5
s_add_u32 s35, s35, 64
v_lshrrev_b32 v38, 1, v0
v_and_b32 v38, 24, v38
v_add_u32 v39, s34, v38
v_add_u32 v40, s35, v38
s_mov_b32 s14, 28311552
s_mov_b32 s15, 0x00020000
s_mov_b32 s26, 192
s_mov_b32 s27, 0x00020000
s_mov_b32 s34, 67584
s_mov_b32 s35, 157696
s_cmp_ge_u32 s28, 2
s_cselect_b32 s34, 67584, s34
s_cselect_b32 s35, 47104, s35
s_add_u32 s60, s34, s47
s_add_u32 s61, s35, s47
s_waitcnt lgkmcnt(0)
s_mov_b32 s16, s6
s_and_b32 s17, s7, 0xffff
buffer_load_dword v19, v37, s[16:19], s45 offen
s_mov_b32 s12, s4
s_and_b32 s13, s5, 0xffff
s_mov_b32 s24, s8
s_and_b32 s25, s9, 0xffff
s_add_u32 s46, s47, 55296
s_add_u32 m0, s47, 145408
s_nop 0
buffer_load_dwordx4 v176, s[16:19], s46 offen offset:0 lds
buffer_load_dwordx4 v177, s[16:19], s46 offen offset:1024 lds
buffer_load_dwordx4 v178, s[16:19], s46 offen offset:2048 lds
buffer_load_dwordx2 v[22:23], v39, s[24:27], 0 offen
buffer_load_dwordx2 v[26:27], v39, s[24:27], 0 offen offset:32
buffer_load_dwordx2 v[30:31], v40, s[24:27], 0 offen
s_add_u32 m0, s42, 0
s_nop 0
buffer_load_dwordx4 v4, s[12:15], s40 offen nt lds
s_add_u32 m0, s42, 2048
s_nop 0
buffer_load_dwordx4 v5, s[12:15], s40 offen nt lds
s_add_u32 m0, s42, 4096
s_nop 0
buffer_load_dwordx4 v6, s[12:15], s40 offen nt lds
s_add_u32 m0, s42, 6144
s_nop 0
buffer_load_dwordx4 v7, s[12:15], s40 offen nt lds
s_add_u32 m0, s43, 8192
s_nop 0
buffer_load_dwordx4 v8, s[12:15], s40 offen nt lds
s_mov_b32 s20, s10
s_and_b32 s21, s11, 0xffff
s_mov_b32 s22, 28311552
s_mov_b32 s23, 0x00020000
s_mov_b32 s36, s4
s_and_b32 s37, s5, 0xffff
s_mov_b32 s39, 0x00020000
v_lshrrev_b32 v37, 4, v0
s_lshl_b32 s34, s29, 7
s_lshl_b32 s35, s29, 5
s_add_u32 s35, s35, 64
v_and_b32 v42, 1, v37
v_lshlrev_b32 v42, 5, v42
v_lshrrev_b32 v43, 2, v36
v_lshl_add_u32 v43, v37, 3, v43
v_mul_u32_u24 v43, 0xc0, v43
v_add_u32 v43, 145408, v43
v_and_b32 v44, 3, v0
v_lshlrev_b32 v44, 3, v44
v_add_u32 v45, s34, v44
v_xor_b32 v45, v45, v42
v_add_u32 v179, v45, v43
v_xor_b32 v45, 32, v45
v_add_u32 v180, v45, v43
v_add_u32 v45, s35, v44
v_xor_b32 v45, v45, v42
v_add_u32 v181, v45, v43
s_mul_i32 s34, s30, 18432
s_sub_u32 s35, 4294930432, s34
s_add_u32 s34, s34, 4294912000
v_add_u32 v182, s35, v179
v_add_u32 v185, s34, v179
v_add_u32 v183, s35, v180
v_add_u32 v186, s34, v180
v_add_u32 v184, s35, v181
v_add_u32 v187, s34, v181
s_mul_i32 s34, s30, 9600
v_add_u32 v43, 0, v36
v_lshrrev_b32 v44, 1, v43
v_and_b32 v44, 2, v44
v_xor_b32 v44, v44, v37
v_lshlrev_b32 v44, 4, v44
v_mul_u32_u24 v43, 0xc0, v43
v_add3_u32 v1, v43, v44, s34
v_add_u32 v43, 1, v36
v_lshrrev_b32 v44, 1, v43
v_and_b32 v44, 2, v44
v_xor_b32 v44, v44, v37
v_lshlrev_b32 v44, 4, v44
v_mul_u32_u24 v43, 0xc0, v43
v_add3_u32 v2, v43, v44, s34
v_add_u32 v43, 2, v36
v_lshrrev_b32 v44, 1, v43
v_and_b32 v44, 2, v44
v_xor_b32 v44, v44, v37
v_lshlrev_b32 v44, 4, v44
v_mul_u32_u24 v43, 0xc0, v43
v_add3_u32 v3, v43, v44, s34
s_mul_i32 s34, s30, 9216
s_add_u32 s34, s34, 130048
v_mul_u32_u24 v41, 0xc0, v36
v_add_u32 v41, s34, v41
v_lshlrev_b32 v43, 3, v36
v_and_b32 v43, 48, v43
v_xor_b32 v44, v39, v43
v_add_u32 v9, v41, v44
v_xor_b32 v44, 32, v44
v_add_u32 v10, v41, v44
v_xor_b32 v44, v40, v43
v_add_u32 v11, v41, v44
s_mul_i32 s35, s29, 4608
s_add_u32 s34, s34, s35
v_lshl_add_u32 v12, v0, 4, s34
s_add_u32 s35, s35, s44
s_mov_b32 s34, 43691
v_mul_u32_u24 v41, s34, v0
v_bfe_u32 v43, v41, 20, 2
v_xor_b32 v43, v43, v0
v_lshl_add_u32 v13, v43, 4, s35
v_add_u32 v41, 2796224, v41
v_bfe_u32 v43, v41, 20, 2
v_xor_b32 v43, v43, v0
v_lshl_add_u32 v14, v43, 4, s35
v_add_u32 v41, 2796224, v41
v_bfe_u32 v43, v41, 20, 2
v_xor_b32 v43, v43, v0
v_lshl_add_u32 v15, v43, 4, s35
v_add_u32 v43, 0x1000, v14
v_cmp_gt_u32 vcc, 32, v0
s_mul_i32 s56, s29, 1536
s_mov_b32 s34, 73728
s_mov_b32 s35, 9600
v_cndmask_b32 v16, v46, v43, vcc
s_cmp_eq_u32 s30, 0
s_cselect_b32 s41, 4294893568, s34
s_cselect_b32 s49, s35, 4294957696
s_sub_u32 s50, 19200, s49
s_add_u32 s59, s56, 6144
s_lshl_b32 s34, s56, 1
s_sub_u32 s48, 3072, s34
s_mul_i32 s31, s29, 52992
s_mul_i32 s32, s29, 4608
s_mul_i32 s34, s29, 57600
s_sub_u32 s33, s59, s34
s_add_u32 s45, s44, 6144
s_mul_i32 s44, s29, s41
s_mov_b32 s57, s40
s_mul_i32 s34, s41, 6
s_add_u32 s58, s40, s34
s_cmp_lt_u32 s58, 28311552
s_cselect_b32 s38, 28311552, 0
s_cselect_b32 s58, s58, 0
s_mov_b32 s34, 104448
s_mov_b32 s35, 83968
s_cmp_ge_u32 s28, 2
s_cselect_b32 s34, 4294961152, s34
s_cselect_b32 s35, 83968, s35
s_add_u32 s62, s34, s47
s_add_u32 s63, s35, s47
s_mov_b32 s34, 122880
s_mov_b32 s35, 120832
s_cmp_ge_u32 s28, 2
s_cselect_b32 s34, 12288, s34
s_cselect_b32 s35, 120832, s35
s_add_u32 s64, s34, s47
s_add_u32 s65, s35, s47
s_mov_b32 s34, 141312
s_mov_b32 s35, 157696
s_cmp_ge_u32 s28, 2
s_cselect_b32 s34, 30720, s34
s_cselect_b32 s35, 47104, s35
s_add_u32 s66, s34, s47
s_add_u32 s67, s35, s47
s_mov_b32 s34, 159744
s_mov_b32 s35, 83968
s_cmp_ge_u32 s28, 2
s_cselect_b32 s34, 153600, s34
s_cselect_b32 s35, 77824, s35
s_add_u32 s68, s34, s47
s_add_u32 s69, s35, s47
s_mov_b32 m0, s61
s_nop 0
buffer_load_dwordx4 v176, s[16:19], s60 offen offset:0 lds
buffer_load_dwordx4 v177, s[16:19], s60 offen offset:1024 lds
buffer_load_dwordx4 v178, s[16:19], s60 offen offset:2048 lds
s_mov_b64 exec, 0
s_cmp_eq_u32 s28, 0
s_cbranch_scc1 Lstub0
s_cmp_eq_u32 s28, 1
s_cbranch_scc1 Lstub1
s_cmp_eq_u32 s28, 2
s_cbranch_scc1 Lstub2
s_branch Lstub3
Lwarmdone:
s_mov_b64 exec, -1
s_add_u32 s46, s47, 79872
s_add_u32 m0, s47, 59392
s_nop 0
buffer_load_dwordx4 v176, s[16:19], s46 offen offset:0 lds
buffer_load_dwordx4 v177, s[16:19], s46 offen offset:1024 lds
buffer_load_dwordx4 v178, s[16:19], s46 offen offset:2048 lds
s_add_u32 s46, s47, 92160
s_add_u32 m0, s47, 71680
s_nop 0
buffer_load_dwordx4 v176, s[16:19], s46 offen offset:0 lds
buffer_load_dwordx4 v177, s[16:19], s46 offen offset:1024 lds
buffer_load_dwordx4 v178, s[16:19], s46 offen offset:2048 lds
s_mov_b32 m0, s63
s_nop 0
buffer_load_dwordx4 v176, s[16:19], s62 offen offset:0 lds
buffer_load_dwordx4 v177, s[16:19], s62 offen offset:1024 lds
buffer_load_dwordx4 v178, s[16:19], s62 offen offset:2048 lds
s_waitcnt vmcnt(17)
v_lshlrev_b32 v28, 16, v30
v_and_b32 v29, 0xffff0000, v30
v_lshlrev_b32 v30, 16, v31
v_and_b32 v31, 0xffff0000, v31
v_lshlrev_b32 v24, 16, v26
v_and_b32 v25, 0xffff0000, v26
v_lshlrev_b32 v26, 16, v27
v_and_b32 v27, 0xffff0000, v27
v_lshlrev_b32 v20, 16, v22
v_and_b32 v21, 0xffff0000, v22
v_lshlrev_b32 v22, 16, v23
v_and_b32 v23, 0xffff0000, v23
s_barrier
ds_read_b64_tr_b16 a[108:109], v179 offset:0
ds_read_b64_tr_b16 a[110:111], v179 offset:768
ds_read_b64_tr_b16 a[120:121], v179 offset:6144
ds_read_b64_tr_b16 a[122:123], v179 offset:6912
ds_read_b64_tr_b16 a[112:113], v180 offset:0
ds_read_b64_tr_b16 a[114:115], v180 offset:768
ds_read_b64_tr_b16 a[124:125], v180 offset:6144
ds_read_b64_tr_b16 a[126:127], v180 offset:6912
ds_read_b64_tr_b16 a[116:117], v181 offset:0
ds_read_b64_tr_b16 a[118:119], v181 offset:768
ds_read_b64_tr_b16 a[128:129], v181 offset:6144
ds_read_b64_tr_b16 a[130:131], v181 offset:6912
s_add_u32 s46, s47, 6144
s_add_u32 m0, s47, 96256
s_waitcnt vmcnt(9)
s_barrier
ds_read_b128 a[216:219], v1 offset:0
ds_read_b128 a[220:223], v1 offset:64
ds_read_b128 a[224:227], v1 offset:128
ds_read_b128 a[228:231], v1 offset:3072
ds_read_b128 a[232:235], v1 offset:3136
ds_read_b64_tr_b16 a[132:133], v179 offset:12288
ds_read_b64_tr_b16 a[134:135], v179 offset:13056
ds_read_b128 a[236:239], v1 offset:3200
Lstub0:
s_cbranch_execz Lstub4
ds_read_b128 a[240:243], v1 offset:6144
ds_read_b128 a[244:247], v1 offset:6208
ds_read_b128 a[248:251], v1 offset:6272
s_waitcnt lgkmcnt(10)
v_mfma_f32_16x16x32_bf16 v[80:83], a[108:111], a[216:219], v[20:23]
buffer_load_dwordx4 v176, s[16:19], s46 offen offset:0 lds
s_waitcnt lgkmcnt(9)
v_mfma_f32_16x16x32_bf16 v[80:83], a[120:123], a[220:223], v[80:83]
ds_read_b64_tr_b16 a[136:137], v180 offset:12288
s_waitcnt lgkmcnt(5)
v_mfma_f32_16x16x32_bf16 v[80:83], a[132:135], a[224:227], v[80:83]
ds_read_b64_tr_b16 a[138:139], v180 offset:13056
v_mfma_f32_16x16x32_bf16 v[92:95], a[108:111], a[228:231], v[20:23]
ds_read_b64_tr_b16 a[140:141], v181 offset:12288
v_mfma_f32_16x16x32_bf16 v[92:95], a[120:123], a[232:235], v[92:95]
buffer_load_dwordx4 v177, s[16:19], s46 offen offset:1024 lds
s_waitcnt lgkmcnt(6)
v_mfma_f32_16x16x32_bf16 v[92:95], a[132:135], a[236:239], v[92:95]
ds_read_b64_tr_b16 a[142:143], v181 offset:13056
s_waitcnt lgkmcnt(4)
v_mfma_f32_16x16x32_bf16 v[104:107], a[108:111], a[240:243], v[20:23]
ds_read_b128 a[252:255], v2 offset:0
v_add_u32 v179, 4294875136, v179
v_mfma_f32_16x16x32_bf16 v[104:107], a[120:123], a[244:247], v[104:107]
ds_read_b128 v[188:191], v2 offset:64
v_add_u32 v180, 4294875136, v180
v_mfma_f32_16x16x32_bf16 v[104:107], a[132:135], a[248:251], v[104:107]
buffer_load_dwordx4 v178, s[16:19], s46 offen offset:2048 lds
s_add_u32 s46, s47, 110592
v_mfma_f32_16x16x32_bf16 v[84:87], a[112:115], a[216:219], v[24:27]
ds_read_b128 v[192:195], v2 offset:128
s_add_u32 m0, s47, 108544
v_mfma_f32_16x16x32_bf16 v[84:87], a[124:127], a[220:223], v[84:87]
ds_read_b128 v[196:199], v2 offset:3072
s_waitcnt lgkmcnt(5)
v_mfma_f32_16x16x32_bf16 v[84:87], a[136:139], a[224:227], v[84:87]
ds_read_b128 v[200:203], v2 offset:3136
v_add_u32 v181, 4294875136, v181
v_mfma_f32_16x16x32_bf16 v[96:99], a[112:115], a[228:231], v[24:27]
buffer_load_dwordx4 v176, s[16:19], s46 offen offset:0 lds
v_mfma_f32_16x16x32_bf16 v[96:99], a[124:127], a[232:235], v[96:99]
ds_read_b128 v[204:207], v2 offset:3200
v_mfma_f32_16x16x32_bf16 v[96:99], a[136:139], a[236:239], v[96:99]
ds_read_b128 v[208:211], v2 offset:6144
v_mfma_f32_16x16x32_bf16 v[108:111], a[112:115], a[240:243], v[24:27]
ds_read_b128 v[212:215], v2 offset:6208
v_mfma_f32_16x16x32_bf16 v[108:111], a[124:127], a[244:247], v[108:111]
s_waitcnt vmcnt(10) lgkmcnt(8)
s_barrier
v_mfma_f32_16x16x32_bf16 v[108:111], a[136:139], a[248:251], v[108:111]
buffer_load_dwordx4 v177, s[16:19], s46 offen offset:1024 lds
v_mfma_f32_16x16x32_bf16 v[88:91], a[116:119], a[216:219], v[28:31]
ds_read_b64_tr_b16 a[144:145], v179 offset:0
ds_read_b64_tr_b16 a[146:147], v179 offset:768
v_mfma_f32_16x16x32_bf16 v[88:91], a[128:131], a[220:223], v[88:91]
ds_read_b64_tr_b16 a[156:157], v179 offset:6144
ds_read_b64_tr_b16 a[158:159], v179 offset:6912
v_mfma_f32_16x16x32_bf16 v[88:91], a[140:143], a[224:227], v[88:91]
ds_read_b64_tr_b16 a[168:169], v179 offset:12288
ds_read_b64_tr_b16 a[170:171], v179 offset:13056
v_mfma_f32_16x16x32_bf16 v[100:103], a[116:119], a[228:231], v[28:31]
buffer_load_dwordx4 v178, s[16:19], s46 offen offset:2048 lds
s_mov_b32 m0, s65
v_mfma_f32_16x16x32_bf16 v[100:103], a[128:131], a[232:235], v[100:103]
ds_read_b128 v[216:219], v2 offset:6272
v_mfma_f32_16x16x32_bf16 v[100:103], a[140:143], a[236:239], v[100:103]
ds_read_b64_tr_b16 a[148:149], v180 offset:0
v_mfma_f32_16x16x32_bf16 v[112:115], a[116:119], a[240:243], v[28:31]
ds_read_b64_tr_b16 a[150:151], v180 offset:768
v_mfma_f32_16x16x32_bf16 v[112:115], a[128:131], a[244:247], v[112:115]
buffer_load_dwordx4 v176, s[16:19], s64 offen offset:0 lds
v_mfma_f32_16x16x32_bf16 v[112:115], a[140:143], a[248:251], v[112:115]
ds_read_b64_tr_b16 a[160:161], v180 offset:6144
s_waitcnt lgkmcnt(4)
v_mfma_f32_16x16x32_bf16 v[80:83], a[144:147], a[252:255], v[80:83]
ds_read_b64_tr_b16 a[162:163], v180 offset:6912
v_mfma_f32_16x16x32_bf16 v[80:83], a[156:159], v[188:191], v[80:83]
ds_read_b64_tr_b16 a[172:173], v180 offset:12288
v_mfma_f32_16x16x32_bf16 v[80:83], a[168:171], v[192:195], v[80:83]
buffer_load_dwordx4 v177, s[16:19], s64 offen offset:1024 lds
ds_read_b64_tr_b16 a[174:175], v180 offset:13056
v_mfma_f32_16x16x32_bf16 v[92:95], a[144:147], v[196:199], v[92:95]
ds_read_b64_tr_b16 a[152:153], v181 offset:0
v_mfma_f32_16x16x32_bf16 v[92:95], a[156:159], v[200:203], v[92:95]
ds_read_b64_tr_b16 a[154:155], v181 offset:768
v_mfma_f32_16x16x32_bf16 v[92:95], a[168:171], v[204:207], v[92:95]
ds_read_b64_tr_b16 a[164:165], v181 offset:6144
v_mfma_f32_16x16x32_bf16 v[104:107], a[144:147], v[208:211], v[104:107]
buffer_load_dwordx4 v178, s[16:19], s64 offen offset:2048 lds
ds_read_b64_tr_b16 a[166:167], v181 offset:6912
v_mfma_f32_16x16x32_bf16 v[104:107], a[156:159], v[212:215], v[104:107]
ds_read_b64_tr_b16 a[176:177], v181 offset:12288
ds_read_b64_tr_b16 a[178:179], v181 offset:13056
s_waitcnt lgkmcnt(7)
v_mfma_f32_16x16x32_bf16 v[104:107], a[168:171], v[216:219], v[104:107]
ds_read_b128 v[220:223], v3 offset:0
s_add_u32 s46, s47, 24576
v_mfma_f32_16x16x32_bf16 v[84:87], a[148:151], a[252:255], v[84:87]
ds_read_b128 v[224:227], v3 offset:64
s_add_u32 m0, s47, 133120
v_mfma_f32_16x16x32_bf16 v[84:87], a[160:163], v[188:191], v[84:87]
buffer_load_dwordx4 v176, s[16:19], s46 offen offset:0 lds
s_waitcnt lgkmcnt(6)
v_mfma_f32_16x16x32_bf16 v[84:87], a[172:175], v[192:195], v[84:87]
ds_read_b128 v[228:231], v3 offset:128
v_mfma_f32_16x16x32_bf16 v[96:99], a[148:151], v[196:199], v[96:99]
ds_read_b128 v[232:235], v3 offset:3072
v_mfma_f32_16x16x32_bf16 v[96:99], a[160:163], v[200:203], v[96:99]
ds_read_b128 v[236:239], v3 offset:3136
v_mfma_f32_16x16x32_bf16 v[96:99], a[172:175], v[204:207], v[96:99]
s_waitcnt vmcnt(10) lgkmcnt(5)
s_barrier
v_mfma_f32_16x16x32_bf16 v[108:111], a[148:151], v[208:211], v[108:111]
buffer_load_dwordx4 v177, s[16:19], s46 offen offset:1024 lds
v_mfma_f32_16x16x32_bf16 v[108:111], a[160:163], v[212:215], v[108:111]
ds_read_b64_tr_b16 a[180:181], v179 offset:18432
v_mfma_f32_16x16x32_bf16 v[108:111], a[172:175], v[216:219], v[108:111]
ds_read_b64_tr_b16 a[182:183], v179 offset:19200
v_mfma_f32_16x16x32_bf16 v[88:91], a[152:155], a[252:255], v[88:91]
ds_read_b64_tr_b16 a[192:193], v179 offset:24576
v_mfma_f32_16x16x32_bf16 v[88:91], a[164:167], v[188:191], v[88:91]
buffer_load_dwordx4 v178, s[16:19], s46 offen offset:2048 lds
ds_read_b64_tr_b16 a[194:195], v179 offset:25344
v_mfma_f32_16x16x32_bf16 v[88:91], a[176:179], v[192:195], v[88:91]
ds_read_b64_tr_b16 a[204:205], v179 offset:30720
ds_read_b64_tr_b16 a[206:207], v179 offset:31488
v_mfma_f32_16x16x32_bf16 v[100:103], a[152:155], v[196:199], v[100:103]
ds_read_b128 v[240:243], v3 offset:3200
s_add_u32 s46, s47, 129024
v_mfma_f32_16x16x32_bf16 v[100:103], a[164:167], v[200:203], v[100:103]
ds_read_b128 v[244:247], v3 offset:6144
s_add_u32 m0, s47, 145408
v_mfma_f32_16x16x32_bf16 v[100:103], a[176:179], v[204:207], v[100:103]
buffer_load_dwordx4 v176, s[16:19], s46 offen offset:0 lds
Lstub1:
s_cbranch_execz Lstub5
ds_read_b128 v[248:251], v3 offset:6208
v_mfma_f32_16x16x32_bf16 v[112:115], a[152:155], v[208:211], v[112:115]
ds_read_b128 v[252:255], v3 offset:6272
v_add_u32 v1, s49, v1
v_mfma_f32_16x16x32_bf16 v[112:115], a[164:167], v[212:215], v[112:115]
ds_read_b64_tr_b16 a[184:185], v180 offset:18432
v_mfma_f32_16x16x32_bf16 v[112:115], a[176:179], v[216:219], v[112:115]
ds_read_b64_tr_b16 a[186:187], v180 offset:19200
s_waitcnt lgkmcnt(6)
v_mfma_f32_16x16x32_bf16 v[80:83], a[180:183], v[220:223], v[80:83]
buffer_load_dwordx4 v177, s[16:19], s46 offen offset:1024 lds
v_mfma_f32_16x16x32_bf16 v[80:83], a[192:195], v[224:227], v[80:83]
ds_read_b64_tr_b16 a[196:197], v180 offset:24576
ds_read_b64_tr_b16 a[198:199], v180 offset:25344
v_mfma_f32_16x16x32_bf16 v[80:83], a[204:207], v[228:231], v[80:83]
ds_read_b64_tr_b16 a[208:209], v180 offset:30720
ds_read_b64_tr_b16 a[210:211], v180 offset:31488
v_mfma_f32_16x16x32_bf16 v[92:95], a[180:183], v[232:235], v[92:95]
ds_read_b64_tr_b16 a[188:189], v181 offset:18432
v_mfma_f32_16x16x32_bf16 v[92:95], a[192:195], v[236:239], v[92:95]
buffer_load_dwordx4 v178, s[16:19], s46 offen offset:2048 lds
s_mov_b32 m0, s67
s_waitcnt lgkmcnt(6)
v_mfma_f32_16x16x32_bf16 v[92:95], a[204:207], v[240:243], v[92:95]
ds_read_b64_tr_b16 a[190:191], v181 offset:19200
ds_read_b64_tr_b16 a[200:201], v181 offset:24576
v_mfma_f32_16x16x32_bf16 v[104:107], a[180:183], v[244:247], v[104:107]
ds_read_b64_tr_b16 a[202:203], v181 offset:25344
ds_read_b64_tr_b16 a[212:213], v181 offset:30720
v_mfma_f32_16x16x32_bf16 v[104:107], a[192:195], v[248:251], v[104:107]
ds_read_b64_tr_b16 a[214:215], v181 offset:31488
v_mfma_f32_16x16x32_bf16 v[104:107], a[204:207], v[252:255], v[104:107]
buffer_load_dwordx4 v176, s[16:19], s66 offen offset:0 lds
s_waitcnt lgkmcnt(6)
v_mfma_f32_16x16x32_bf16 v[84:87], a[184:187], v[220:223], v[84:87]
ds_read_b128 v[32:35], v1 offset:0
v_mfma_f32_16x16x32_bf16 v[84:87], a[196:199], v[224:227], v[84:87]
ds_read_b128 v[36:39], v1 offset:64
v_mfma_f32_16x16x32_bf16 v[84:87], a[208:211], v[228:231], v[84:87]
ds_read_b128 v[40:43], v1 offset:128
v_mfma_f32_16x16x32_bf16 v[96:99], a[184:187], v[232:235], v[96:99]
buffer_load_dwordx4 v177, s[16:19], s66 offen offset:1024 lds
v_mfma_f32_16x16x32_bf16 v[96:99], a[196:199], v[236:239], v[96:99]
s_waitcnt vmcnt(8) lgkmcnt(3)
s_barrier
v_mfma_f32_16x16x32_bf16 v[96:99], a[208:211], v[240:243], v[96:99]
ds_read_b64_tr_b16 a[0:1], v182 offset:0
v_mfma_f32_16x16x32_bf16 v[108:111], a[184:187], v[244:247], v[108:111]
ds_read_b64_tr_b16 a[2:3], v182 offset:768
v_mfma_f32_16x16x32_bf16 v[108:111], a[196:199], v[248:251], v[108:111]
buffer_load_dwordx4 v178, s[16:19], s66 offen offset:2048 lds
s_add_u32 s46, s47, 43008
v_mfma_f32_16x16x32_bf16 v[108:111], a[208:211], v[252:255], v[108:111]
ds_read_b64_tr_b16 a[12:13], v182 offset:6144
s_add_u32 m0, s47, 59392
v_mfma_f32_16x16x32_bf16 v[88:91], a[188:191], v[220:223], v[88:91]
ds_read_b64_tr_b16 a[14:15], v182 offset:6912
v_mfma_f32_16x16x32_bf16 v[88:91], a[200:203], v[224:227], v[88:91]
ds_read_b64_tr_b16 a[24:25], v182 offset:12288
v_mfma_f32_16x16x32_bf16 v[88:91], a[212:215], v[228:231], v[88:91]
buffer_load_dwordx4 v176, s[16:19], s46 offen offset:0 lds
ds_read_b64_tr_b16 a[26:27], v182 offset:13056
v_mfma_f32_16x16x32_bf16 v[100:103], a[188:191], v[232:235], v[100:103]
ds_read_b64_tr_b16 a[4:5], v183 offset:0
v_mfma_f32_16x16x32_bf16 v[100:103], a[200:203], v[236:239], v[100:103]
ds_read_b64_tr_b16 a[6:7], v183 offset:768
v_mfma_f32_16x16x32_bf16 v[100:103], a[212:215], v[240:243], v[100:103]
ds_read_b64_tr_b16 a[16:17], v183 offset:6144
v_mfma_f32_16x16x32_bf16 v[112:115], a[188:191], v[244:247], v[112:115]
buffer_load_dwordx4 v177, s[16:19], s46 offen offset:1024 lds
v_mfma_f32_16x16x32_bf16 v[112:115], a[200:203], v[248:251], v[112:115]
ds_read_b64_tr_b16 a[18:19], v183 offset:6912
v_mfma_f32_16x16x32_bf16 v[112:115], a[212:215], v[252:255], v[112:115]
ds_read_b64_tr_b16 a[28:29], v183 offset:12288
s_waitcnt lgkmcnt(5)
v_mfma_f32_16x16x32_bf16 v[116:119], a[0:3], a[216:219], v[20:23]
ds_read_b64_tr_b16 a[30:31], v183 offset:13056
v_mfma_f32_16x16x32_bf16 v[116:119], a[12:15], a[220:223], v[116:119]
buffer_load_dwordx4 v178, s[16:19], s46 offen offset:2048 lds
s_add_u32 s46, s47, 147456
v_mfma_f32_16x16x32_bf16 v[116:119], a[24:27], a[224:227], v[116:119]
ds_read_b64_tr_b16 a[8:9], v184 offset:0
s_add_u32 m0, s47, 71680
v_mfma_f32_16x16x32_bf16 v[128:131], a[0:3], a[228:231], v[20:23]
ds_read_b64_tr_b16 a[10:11], v184 offset:768
v_mfma_f32_16x16x32_bf16 v[128:131], a[12:15], a[232:235], v[128:131]
ds_read_b64_tr_b16 a[20:21], v184 offset:6144
v_mfma_f32_16x16x32_bf16 v[128:131], a[24:27], a[236:239], v[128:131]
buffer_load_dwordx4 v176, s[16:19], s46 offen offset:0 lds
v_mfma_f32_16x16x32_bf16 v[140:143], a[0:3], a[240:243], v[20:23]
ds_read_b64_tr_b16 a[22:23], v184 offset:6912
v_mfma_f32_16x16x32_bf16 v[140:143], a[12:15], a[244:247], v[140:143]
ds_read_b64_tr_b16 a[32:33], v184 offset:12288
v_mfma_f32_16x16x32_bf16 v[140:143], a[24:27], a[248:251], v[140:143]
ds_read_b64_tr_b16 a[34:35], v184 offset:13056
s_waitcnt lgkmcnt(5)
v_mfma_f32_16x16x32_bf16 v[120:123], a[4:7], a[216:219], v[24:27]
buffer_load_dwordx4 v177, s[16:19], s46 offen offset:1024 lds
v_mfma_f32_16x16x32_bf16 v[120:123], a[16:19], a[220:223], v[120:123]
ds_read_b128 v[44:47], v1 offset:3072
v_mfma_f32_16x16x32_bf16 v[120:123], a[28:31], a[224:227], v[120:123]
ds_read_b128 v[48:51], v1 offset:3136
v_mfma_f32_16x16x32_bf16 v[132:135], a[4:7], a[228:231], v[24:27]
ds_read_b128 v[52:55], v1 offset:3200
v_mfma_f32_16x16x32_bf16 v[132:135], a[16:19], a[232:235], v[132:135]
buffer_load_dwordx4 v178, s[16:19], s46 offen offset:2048 lds
s_mov_b32 m0, s69
v_mfma_f32_16x16x32_bf16 v[132:135], a[28:31], a[236:239], v[132:135]
ds_read_b128 v[56:59], v1 offset:6144
v_mfma_f32_16x16x32_bf16 v[144:147], a[4:7], a[240:243], v[24:27]
ds_read_b128 v[60:63], v1 offset:6208
v_mfma_f32_16x16x32_bf16 v[144:147], a[16:19], a[244:247], v[144:147]
ds_read_b128 v[64:67], v1 offset:6272
v_add_u32 v2, s49, v2
v_mfma_f32_16x16x32_bf16 v[144:147], a[28:31], a[248:251], v[144:147]
buffer_load_dwordx4 v176, s[16:19], s68 offen offset:0 lds
s_waitcnt lgkmcnt(4)
v_mfma_f32_16x16x32_bf16 v[124:127], a[8:11], a[216:219], v[28:31]
ds_read_b128 v[68:71], v2 offset:0
v_mfma_f32_16x16x32_bf16 v[124:127], a[20:23], a[220:223], v[124:127]
ds_read_b128 v[72:75], v2 offset:64
v_mfma_f32_16x16x32_bf16 v[124:127], a[32:35], a[224:227], v[124:127]
ds_read_b128 v[76:79], v2 offset:128
v_mfma_f32_16x16x32_bf16 v[136:139], a[8:11], a[228:231], v[28:31]
buffer_load_dwordx4 v177, s[16:19], s68 offen offset:1024 lds
v_mfma_f32_16x16x32_bf16 v[136:139], a[20:23], a[232:235], v[136:139]
ds_read_b64_tr_b16 a[216:217], v185 offset:0
v_mfma_f32_16x16x32_bf16 v[136:139], a[32:35], a[236:239], v[136:139]
ds_read_b64_tr_b16 a[218:219], v185 offset:768
v_mfma_f32_16x16x32_bf16 v[148:151], a[8:11], a[240:243], v[28:31]
ds_read_b64_tr_b16 a[220:221], v186 offset:0
v_mfma_f32_16x16x32_bf16 v[148:151], a[20:23], a[244:247], v[148:151]
buffer_load_dwordx4 v178, s[16:19], s68 offen offset:2048 lds
s_add_u32 s40, s40, s41
Lstub2:
s_cbranch_execz Lstub6
v_mfma_f32_16x16x32_bf16 v[148:151], a[32:35], a[248:251], v[148:151]
ds_read_b64_tr_b16 a[222:223], v186 offset:768
s_add_u32 m0, s42, 19200
v_mfma_f32_16x16x32_bf16 v[80:83], a[0:3], v[32:35], v[80:83]
ds_read_b64_tr_b16 a[224:225], v187 offset:0
v_mfma_f32_16x16x32_bf16 v[80:83], a[12:15], v[36:39], v[80:83]
ds_read_b64_tr_b16 a[226:227], v187 offset:768
v_mfma_f32_16x16x32_bf16 v[80:83], a[24:27], v[40:43], v[80:83]
buffer_load_dwordx4 v4, s[12:15], s40 offen nt lds
s_add_u32 m0, s42, 21248
v_mfma_f32_16x16x32_bf16 v[92:95], a[0:3], v[44:47], v[92:95]
ds_read_b64_tr_b16 a[228:229], v185 offset:6144
v_mfma_f32_16x16x32_bf16 v[92:95], a[12:15], v[48:51], v[92:95]
ds_read_b64_tr_b16 a[230:231], v185 offset:6912
s_waitcnt lgkmcnt(5)
v_mfma_f32_16x16x32_bf16 v[92:95], a[24:27], v[52:55], v[92:95]
ds_read_b64_tr_b16 a[232:233], v186 offset:6144
v_mfma_f32_16x16x32_bf16 v[104:107], a[0:3], v[56:59], v[104:107]
buffer_load_dwordx4 v5, s[12:15], s40 offen nt lds
s_add_u32 m0, s42, 23296
v_mfma_f32_16x16x32_bf16 v[104:107], a[12:15], v[60:63], v[104:107]
ds_read_b64_tr_b16 a[234:235], v186 offset:6912
v_mfma_f32_16x16x32_bf16 v[104:107], a[24:27], v[64:67], v[104:107]
ds_read_b64_tr_b16 a[236:237], v187 offset:6144
v_mfma_f32_16x16x32_bf16 v[84:87], a[4:7], v[32:35], v[84:87]
ds_read_b64_tr_b16 a[238:239], v187 offset:6912
v_mfma_f32_16x16x32_bf16 v[84:87], a[16:19], v[36:39], v[84:87]
buffer_load_dwordx4 v6, s[12:15], s40 offen nt lds
s_add_u32 m0, s42, 25344
v_mfma_f32_16x16x32_bf16 v[84:87], a[28:31], v[40:43], v[84:87]
ds_read_b64_tr_b16 a[240:241], v185 offset:12288
v_mfma_f32_16x16x32_bf16 v[96:99], a[4:7], v[44:47], v[96:99]
ds_read_b64_tr_b16 a[242:243], v185 offset:13056
v_mfma_f32_16x16x32_bf16 v[96:99], a[16:19], v[48:51], v[96:99]
s_waitcnt vmcnt(12)
s_barrier
v_mfma_f32_16x16x32_bf16 v[96:99], a[28:31], v[52:55], v[96:99]
buffer_load_dwordx4 v7, s[12:15], s40 offen nt lds
s_add_u32 m0, s43, 27392
v_mfma_f32_16x16x32_bf16 v[108:111], a[4:7], v[56:59], v[108:111]
ds_read_b64_tr_b16 a[36:37], v182 offset:36864
v_mfma_f32_16x16x32_bf16 v[108:111], a[16:19], v[60:63], v[108:111]
ds_read_b64_tr_b16 a[38:39], v182 offset:37632
v_mfma_f32_16x16x32_bf16 v[108:111], a[28:31], v[64:67], v[108:111]
ds_read_b64_tr_b16 a[48:49], v182 offset:43008
v_mfma_f32_16x16x32_bf16 v[88:91], a[8:11], v[32:35], v[88:91]
buffer_load_dwordx4 v8, s[12:15], s40 offen nt lds
v_mfma_f32_16x16x32_bf16 v[88:91], a[20:23], v[36:39], v[88:91]
ds_read_b64_tr_b16 a[50:51], v182 offset:43776
v_mfma_f32_16x16x32_bf16 v[88:91], a[32:35], v[40:43], v[88:91]
ds_read_b64_tr_b16 a[60:61], v182 offset:49152
ds_read_b64_tr_b16 a[62:63], v182 offset:49920
v_mfma_f32_16x16x32_bf16 v[100:103], a[8:11], v[44:47], v[100:103]
ds_read_b64_tr_b16 a[40:41], v183 offset:36864
v_mfma_f32_16x16x32_bf16 v[100:103], a[20:23], v[48:51], v[100:103]
ds_read_b64_tr_b16 a[42:43], v183 offset:37632
v_mfma_f32_16x16x32_bf16 v[100:103], a[32:35], v[52:55], v[100:103]
ds_read_b64_tr_b16 a[52:53], v183 offset:43008
v_mfma_f32_16x16x32_bf16 v[112:115], a[8:11], v[56:59], v[112:115]
ds_read_b64_tr_b16 a[54:55], v183 offset:43776
v_mfma_f32_16x16x32_bf16 v[112:115], a[20:23], v[60:63], v[112:115]
ds_read_b64_tr_b16 a[64:65], v183 offset:49152
v_mfma_f32_16x16x32_bf16 v[112:115], a[32:35], v[64:67], v[112:115]
ds_read_b64_tr_b16 a[66:67], v183 offset:49920
s_waitcnt lgkmcnt(6)
v_mfma_f32_16x16x32_bf16 v[116:119], a[36:39], a[252:255], v[116:119]
ds_read_b64_tr_b16 a[44:45], v184 offset:36864
v_mfma_f32_16x16x32_bf16 v[116:119], a[48:51], v[188:191], v[116:119]
ds_read_b64_tr_b16 a[46:47], v184 offset:37632
v_mfma_f32_16x16x32_bf16 v[116:119], a[60:63], v[192:195], v[116:119]
ds_read_b64_tr_b16 a[56:57], v184 offset:43008
v_mfma_f32_16x16x32_bf16 v[128:131], a[36:39], v[196:199], v[128:131]
ds_read_b64_tr_b16 a[58:59], v184 offset:43776
v_mfma_f32_16x16x32_bf16 v[128:131], a[48:51], v[200:203], v[128:131]
ds_read_b64_tr_b16 a[68:69], v184 offset:49152
v_mfma_f32_16x16x32_bf16 v[128:131], a[60:63], v[204:207], v[128:131]
ds_read_b64_tr_b16 a[70:71], v184 offset:49920
v_add_u32 v182, 4294930432, v182
v_mfma_f32_16x16x32_bf16 v[140:143], a[36:39], v[208:211], v[140:143]
ds_read_b128 v[32:35], v2 offset:3072
v_add_u32 v183, 4294930432, v183
v_mfma_f32_16x16x32_bf16 v[140:143], a[48:51], v[212:215], v[140:143]
ds_read_b128 v[36:39], v2 offset:3136
v_add_u32 v184, 4294930432, v184
v_mfma_f32_16x16x32_bf16 v[140:143], a[60:63], v[216:219], v[140:143]
ds_read_b128 v[40:43], v2 offset:3200
s_waitcnt lgkmcnt(6)
v_mfma_f32_16x16x32_bf16 v[120:123], a[40:43], a[252:255], v[120:123]
ds_read_b128 v[44:47], v2 offset:6144
v_mfma_f32_16x16x32_bf16 v[120:123], a[52:55], v[188:191], v[120:123]
ds_read_b128 v[48:51], v2 offset:6208
v_mfma_f32_16x16x32_bf16 v[120:123], a[64:67], v[192:195], v[120:123]
ds_read_b128 v[52:55], v2 offset:6272
v_add_u32 v3, s49, v3
v_mfma_f32_16x16x32_bf16 v[132:135], a[40:43], v[196:199], v[132:135]
ds_read_b128 v[56:59], v3 offset:0
v_mfma_f32_16x16x32_bf16 v[132:135], a[52:55], v[200:203], v[132:135]
ds_read_b128 v[60:63], v3 offset:64
v_mfma_f32_16x16x32_bf16 v[132:135], a[64:67], v[204:207], v[132:135]
ds_read_b128 v[64:67], v3 offset:128
v_mfma_f32_16x16x32_bf16 v[144:147], a[40:43], v[208:211], v[144:147]
ds_read_b64_tr_b16 a[244:245], v186 offset:12288
v_mfma_f32_16x16x32_bf16 v[144:147], a[52:55], v[212:215], v[144:147]
ds_read_b64_tr_b16 a[246:247], v186 offset:13056
v_mfma_f32_16x16x32_bf16 v[144:147], a[64:67], v[216:219], v[144:147]
ds_read_b64_tr_b16 a[248:249], v187 offset:12288
v_mfma_f32_16x16x32_bf16 v[124:127], a[44:47], a[252:255], v[124:127]
ds_read_b64_tr_b16 a[250:251], v187 offset:13056
s_waitcnt lgkmcnt(6)
v_mfma_f32_16x16x32_bf16 v[124:127], a[56:59], v[188:191], v[124:127]
ds_read_b64_tr_b16 a[252:253], v185 offset:36864
v_mfma_f32_16x16x32_bf16 v[124:127], a[68:71], v[192:195], v[124:127]
ds_read_b64_tr_b16 a[254:255], v185 offset:37632
v_mfma_f32_16x16x32_bf16 v[136:139], a[44:47], v[196:199], v[136:139]
ds_read_b64_tr_b16 v[188:189], v186 offset:36864
v_mfma_f32_16x16x32_bf16 v[136:139], a[56:59], v[200:203], v[136:139]
ds_read_b64_tr_b16 v[190:191], v186 offset:37632
v_mfma_f32_16x16x32_bf16 v[136:139], a[68:71], v[204:207], v[136:139]
ds_read_b64_tr_b16 v[192:193], v187 offset:36864
v_mfma_f32_16x16x32_bf16 v[148:151], a[44:47], v[208:211], v[148:151]
ds_read_b64_tr_b16 v[194:195], v187 offset:37632
v_mfma_f32_16x16x32_bf16 v[148:151], a[56:59], v[212:215], v[148:151]
ds_read_b64_tr_b16 v[196:197], v185 offset:43008
v_mfma_f32_16x16x32_bf16 v[148:151], a[68:71], v[216:219], v[148:151]
ds_read_b64_tr_b16 v[198:199], v185 offset:43776
v_mfma_f32_16x16x32_bf16 v[80:83], a[36:39], v[68:71], v[80:83]
ds_read_b64_tr_b16 v[200:201], v186 offset:43008
v_mfma_f32_16x16x32_bf16 v[80:83], a[48:51], v[72:75], v[80:83]
ds_read_b64_tr_b16 v[202:203], v186 offset:43776
v_mfma_f32_16x16x32_bf16 v[80:83], a[60:63], v[76:79], v[80:83]
ds_read_b64_tr_b16 v[204:205], v187 offset:43008
Lstub3:
s_cbranch_execz Lstub7
v_mfma_f32_16x16x32_bf16 v[92:95], a[36:39], v[32:35], v[92:95]
ds_read_b64_tr_b16 v[206:207], v187 offset:43776
v_mfma_f32_16x16x32_bf16 v[92:95], a[48:51], v[36:39], v[92:95]
ds_read_b64_tr_b16 v[208:209], v185 offset:49152
v_mfma_f32_16x16x32_bf16 v[92:95], a[60:63], v[40:43], v[92:95]
ds_read_b64_tr_b16 v[210:211], v185 offset:49920
v_mfma_f32_16x16x32_bf16 v[104:107], a[36:39], v[44:47], v[104:107]
ds_read_b64_tr_b16 v[212:213], v186 offset:49152
v_mfma_f32_16x16x32_bf16 v[104:107], a[48:51], v[48:51], v[104:107]
ds_read_b64_tr_b16 v[214:215], v186 offset:49920
v_mfma_f32_16x16x32_bf16 v[104:107], a[60:63], v[52:55], v[104:107]
ds_read_b64_tr_b16 v[216:217], v187 offset:49152
v_mfma_f32_16x16x32_bf16 v[84:87], a[40:43], v[68:71], v[84:87]
ds_read_b64_tr_b16 v[218:219], v187 offset:49920
v_add_u32 v185, 4294930432, v185
v_mfma_f32_16x16x32_bf16 v[84:87], a[52:55], v[72:75], v[84:87]
v_add_u32 v186, 4294930432, v186
v_add_u32 v187, 4294930432, v187
v_mfma_f32_16x16x32_bf16 v[84:87], a[64:67], v[76:79], v[84:87]
v_mfma_f32_16x16x32_bf16 v[96:99], a[40:43], v[32:35], v[96:99]
v_mfma_f32_16x16x32_bf16 v[96:99], a[52:55], v[36:39], v[96:99]
s_waitcnt vmcnt(5)
s_barrier
v_mfma_f32_16x16x32_bf16 v[96:99], a[64:67], v[40:43], v[96:99]
ds_read_b64_tr_b16 a[72:73], v182 offset:0
v_mfma_f32_16x16x32_bf16 v[108:111], a[40:43], v[44:47], v[108:111]
ds_read_b64_tr_b16 a[74:75], v182 offset:768
v_mfma_f32_16x16x32_bf16 v[108:111], a[52:55], v[48:51], v[108:111]
ds_read_b64_tr_b16 a[84:85], v182 offset:6144
v_mfma_f32_16x16x32_bf16 v[108:111], a[64:67], v[52:55], v[108:111]
ds_read_b64_tr_b16 a[86:87], v182 offset:6912
v_mfma_f32_16x16x32_bf16 v[88:91], a[44:47], v[68:71], v[88:91]
ds_read_b64_tr_b16 a[96:97], v182 offset:12288
v_mfma_f32_16x16x32_bf16 v[88:91], a[56:59], v[72:75], v[88:91]
ds_read_b64_tr_b16 a[98:99], v182 offset:13056
v_mfma_f32_16x16x32_bf16 v[88:91], a[68:71], v[76:79], v[88:91]
ds_read_b64_tr_b16 a[76:77], v183 offset:0
v_mfma_f32_16x16x32_bf16 v[100:103], a[44:47], v[32:35], v[100:103]
ds_read_b64_tr_b16 a[78:79], v183 offset:768
v_mfma_f32_16x16x32_bf16 v[100:103], a[56:59], v[36:39], v[100:103]
ds_read_b64_tr_b16 a[88:89], v183 offset:6144
v_mfma_f32_16x16x32_bf16 v[100:103], a[68:71], v[40:43], v[100:103]
ds_read_b64_tr_b16 a[90:91], v183 offset:6912
v_mfma_f32_16x16x32_bf16 v[112:115], a[44:47], v[44:47], v[112:115]
ds_read_b64_tr_b16 a[100:101], v183 offset:12288
v_mfma_f32_16x16x32_bf16 v[112:115], a[56:59], v[48:51], v[112:115]
ds_read_b64_tr_b16 a[102:103], v183 offset:13056
v_mfma_f32_16x16x32_bf16 v[112:115], a[68:71], v[52:55], v[112:115]
ds_read_b64_tr_b16 a[80:81], v184 offset:0
s_waitcnt lgkmcnt(6)
v_mfma_f32_16x16x32_bf16 v[116:119], a[72:75], v[220:223], v[116:119]
ds_read_b64_tr_b16 a[82:83], v184 offset:768
v_mfma_f32_16x16x32_bf16 v[116:119], a[84:87], v[224:227], v[116:119]
ds_read_b64_tr_b16 a[92:93], v184 offset:6144
v_mfma_f32_16x16x32_bf16 v[116:119], a[96:99], v[228:231], v[116:119]
ds_read_b64_tr_b16 a[94:95], v184 offset:6912
v_mfma_f32_16x16x32_bf16 v[128:131], a[72:75], v[232:235], v[128:131]
ds_read_b64_tr_b16 a[104:105], v184 offset:12288
v_mfma_f32_16x16x32_bf16 v[128:131], a[84:87], v[236:239], v[128:131]
ds_read_b64_tr_b16 a[106:107], v184 offset:13056
v_mfma_f32_16x16x32_bf16 v[128:131], a[96:99], v[240:243], v[128:131]
ds_read_b128 v[68:71], v3 offset:3072
v_mfma_f32_16x16x32_bf16 v[140:143], a[72:75], v[244:247], v[140:143]
ds_read_b128 v[72:75], v3 offset:3136
v_mfma_f32_16x16x32_bf16 v[140:143], a[84:87], v[248:251], v[140:143]
ds_read_b128 v[76:79], v3 offset:3200
v_mfma_f32_16x16x32_bf16 v[140:143], a[96:99], v[252:255], v[140:143]
ds_read_b128 v[32:35], v3 offset:6144
s_waitcnt lgkmcnt(6)
v_mfma_f32_16x16x32_bf16 v[120:123], a[76:79], v[220:223], v[120:123]
ds_read_b128 v[36:39], v3 offset:6208
v_mfma_f32_16x16x32_bf16 v[120:123], a[88:91], v[224:227], v[120:123]
ds_read_b128 v[40:43], v3 offset:6272
v_add_u32 v1, s50, v1
v_mfma_f32_16x16x32_bf16 v[120:123], a[100:103], v[228:231], v[120:123]
v_add_u32 v2, s50, v2
v_add_u32 v3, s50, v3
v_mfma_f32_16x16x32_bf16 v[132:135], a[76:79], v[232:235], v[132:135]
v_mfma_f32_16x16x32_bf16 v[132:135], a[88:91], v[236:239], v[132:135]
v_mfma_f32_16x16x32_bf16 v[132:135], a[100:103], v[240:243], v[132:135]
v_mfma_f32_16x16x32_bf16 v[144:147], a[76:79], v[244:247], v[144:147]
v_mfma_f32_16x16x32_bf16 v[144:147], a[88:91], v[248:251], v[144:147]
v_mfma_f32_16x16x32_bf16 v[144:147], a[100:103], v[252:255], v[144:147]
v_mfma_f32_16x16x32_bf16 v[124:127], a[80:83], v[220:223], v[124:127]
ds_read_b64_tr_b16 v[220:221], v185 offset:0
v_mfma_f32_16x16x32_bf16 v[124:127], a[92:95], v[224:227], v[124:127]
ds_read_b64_tr_b16 v[222:223], v185 offset:768
s_waitcnt lgkmcnt(2)
v_mfma_f32_16x16x32_bf16 v[124:127], a[104:107], v[228:231], v[124:127]
ds_read_b64_tr_b16 v[224:225], v186 offset:0
v_mfma_f32_16x16x32_bf16 v[136:139], a[80:83], v[232:235], v[136:139]
ds_read_b64_tr_b16 v[226:227], v186 offset:768
v_mfma_f32_16x16x32_bf16 v[136:139], a[92:95], v[236:239], v[136:139]
ds_read_b64_tr_b16 v[228:229], v187 offset:0
v_mfma_f32_16x16x32_bf16 v[136:139], a[104:107], v[240:243], v[136:139]
ds_read_b64_tr_b16 v[230:231], v187 offset:768
v_mfma_f32_16x16x32_bf16 v[148:151], a[80:83], v[244:247], v[148:151]
ds_read_b64_tr_b16 v[232:233], v185 offset:6144
v_mfma_f32_16x16x32_bf16 v[148:151], a[92:95], v[248:251], v[148:151]
ds_read_b64_tr_b16 v[234:235], v185 offset:6912
v_mfma_f32_16x16x32_bf16 v[148:151], a[104:107], v[252:255], v[148:151]
ds_read_b64_tr_b16 v[236:237], v186 offset:6144
v_mfma_f32_16x16x32_bf16 v[80:83], a[72:75], v[56:59], v[80:83]
ds_read_b64_tr_b16 v[238:239], v186 offset:6912
v_mfma_f32_16x16x32_bf16 v[80:83], a[84:87], v[60:63], v[80:83]
ds_read_b64_tr_b16 v[240:241], v187 offset:6144
v_mfma_f32_16x16x32_bf16 v[80:83], a[96:99], v[64:67], v[80:83]
ds_read_b64_tr_b16 v[242:243], v187 offset:6912
v_mfma_f32_16x16x32_bf16 v[92:95], a[72:75], v[68:71], v[92:95]
ds_read_b64_tr_b16 v[244:245], v185 offset:12288
v_mfma_f32_16x16x32_bf16 v[92:95], a[84:87], v[72:75], v[92:95]
ds_read_b64_tr_b16 v[246:247], v185 offset:13056
v_mfma_f32_16x16x32_bf16 v[92:95], a[96:99], v[76:79], v[92:95]
ds_read_b64_tr_b16 v[248:249], v186 offset:12288
v_mfma_f32_16x16x32_bf16 v[104:107], a[72:75], v[32:35], v[104:107]
ds_read_b64_tr_b16 v[250:251], v186 offset:13056
v_mfma_f32_16x16x32_bf16 v[104:107], a[84:87], v[36:39], v[104:107]
ds_read_b64_tr_b16 v[252:253], v187 offset:12288
ds_read_b64_tr_b16 v[254:255], v187 offset:13056
v_mfma_f32_16x16x32_bf16 v[104:107], a[96:99], v[40:43], v[104:107]
v_mfma_f32_16x16x32_bf16 v[84:87], a[76:79], v[56:59], v[84:87]
v_mfma_f32_16x16x32_bf16 v[84:87], a[88:91], v[60:63], v[84:87]
v_mfma_f32_16x16x32_bf16 v[84:87], a[100:103], v[64:67], v[84:87]
s_waitcnt vmcnt(0) lgkmcnt(0)
s_barrier
v_mfma_f32_16x16x32_bf16 v[96:99], a[76:79], v[68:71], v[96:99]
ds_read_b128 v[44:47], v1 offset:0
s_add_u32 s40, s40, s41
v_mfma_f32_16x16x32_bf16 v[96:99], a[88:91], v[72:75], v[96:99]
ds_read_b128 v[48:51], v1 offset:64
s_add_u32 m0, s42, 0
v_mfma_f32_16x16x32_bf16 v[96:99], a[100:103], v[76:79], v[96:99]
ds_read_b128 v[52:55], v1 offset:128
v_mfma_f32_16x16x32_bf16 v[108:111], a[76:79], v[32:35], v[108:111]
Lstub4:
s_cbranch_execz Lstub8
buffer_load_dwordx4 v4, s[12:15], s40 offen nt lds
s_add_u32 m0, s42, 2048
v_mfma_f32_16x16x32_bf16 v[108:111], a[88:91], v[36:39], v[108:111]
v_mfma_f32_16x16x32_bf16 v[108:111], a[100:103], v[40:43], v[108:111]
v_mfma_f32_16x16x32_bf16 v[88:91], a[80:83], v[56:59], v[88:91]
ds_read_b128 v[56:59], v2 offset:0
v_mfma_f32_16x16x32_bf16 v[88:91], a[92:95], v[60:63], v[88:91]
ds_read_b128 v[60:63], v2 offset:64
v_mfma_f32_16x16x32_bf16 v[88:91], a[104:107], v[64:67], v[88:91]
ds_read_b128 v[64:67], v2 offset:128
v_mfma_f32_16x16x32_bf16 v[100:103], a[80:83], v[68:71], v[100:103]
ds_read_b128 v[68:71], v3 offset:0
v_mfma_f32_16x16x32_bf16 v[100:103], a[92:95], v[72:75], v[100:103]
ds_read_b128 v[72:75], v3 offset:64
v_mfma_f32_16x16x32_bf16 v[100:103], a[104:107], v[76:79], v[100:103]
ds_read_b128 v[76:79], v3 offset:128
v_mfma_f32_16x16x32_bf16 v[112:115], a[80:83], v[32:35], v[112:115]
ds_read_b128 v[32:35], v1 offset:3072
v_mfma_f32_16x16x32_bf16 v[112:115], a[92:95], v[36:39], v[112:115]
ds_read_b128 v[36:39], v1 offset:3136
v_mfma_f32_16x16x32_bf16 v[112:115], a[104:107], v[40:43], v[112:115]
ds_read_b128 v[40:43], v1 offset:3200
s_waitcnt lgkmcnt(6)
v_mfma_f32_16x16x32_bf16 v[88:91], a[224:227], v[44:47], v[88:91]
v_mfma_f32_16x16x32_bf16 v[88:91], a[236:239], v[48:51], v[88:91]
v_mfma_f32_16x16x32_bf16 v[88:91], a[248:251], v[52:55], v[88:91]
v_mfma_f32_16x16x32_bf16 v[88:91], v[192:195], v[56:59], v[88:91]
v_mfma_f32_16x16x32_bf16 v[88:91], v[204:207], v[60:63], v[88:91]
buffer_load_dwordx4 v5, s[12:15], s40 offen nt lds
s_add_u32 m0, s42, 4096
v_mfma_f32_16x16x32_bf16 v[88:91], v[216:219], v[64:67], v[88:91]
s_waitcnt lgkmcnt(0)
v_mfma_f32_16x16x32_bf16 v[88:91], v[228:231], v[68:71], v[88:91]
v_mfma_f32_16x16x32_bf16 v[88:91], v[240:243], v[72:75], v[88:91]
v_mfma_f32_16x16x32_bf16 v[88:91], v[252:255], v[76:79], v[88:91]
v_mfma_f32_16x16x32_bf16 v[80:83], a[216:219], v[44:47], v[80:83]
v_mfma_f32_16x16x32_bf16 v[80:83], a[228:231], v[48:51], v[80:83]
v_mfma_f32_16x16x32_bf16 v[80:83], a[240:243], v[52:55], v[80:83]
v_mfma_f32_16x16x32_bf16 v[80:83], a[252:255], v[56:59], v[80:83]
v_mfma_f32_16x16x32_bf16 v[80:83], v[196:199], v[60:63], v[80:83]
v_mfma_f32_16x16x32_bf16 v[80:83], v[208:211], v[64:67], v[80:83]
v_mfma_f32_16x16x32_bf16 v[80:83], v[220:223], v[68:71], v[80:83]
v_mfma_f32_16x16x32_bf16 v[80:83], v[232:235], v[72:75], v[80:83]
v_cvt_pk_bf16_f32 v88, v88, v89
v_cvt_pk_bf16_f32 v89, v90, v91
v_mfma_f32_16x16x32_bf16 v[80:83], v[244:247], v[76:79], v[80:83]
ds_write_b32 v11, v88 offset:0
v_mfma_f32_16x16x32_bf16 v[84:87], a[220:223], v[44:47], v[84:87]
ds_write_b32 v11, v89 offset:4
v_mfma_f32_16x16x32_bf16 v[84:87], a[232:235], v[48:51], v[84:87]
v_mfma_f32_16x16x32_bf16 v[84:87], a[244:247], v[52:55], v[84:87]
buffer_load_dwordx4 v6, s[12:15], s40 offen nt lds
s_add_u32 m0, s42, 6144
v_mfma_f32_16x16x32_bf16 v[84:87], v[188:191], v[56:59], v[84:87]
v_mfma_f32_16x16x32_bf16 v[84:87], v[200:203], v[60:63], v[84:87]
v_mfma_f32_16x16x32_bf16 v[84:87], v[212:215], v[64:67], v[84:87]
v_mfma_f32_16x16x32_bf16 v[84:87], v[224:227], v[68:71], v[84:87]
v_mfma_f32_16x16x32_bf16 v[84:87], v[236:239], v[72:75], v[84:87]
v_cvt_pk_bf16_f32 v80, v80, v81
v_cvt_pk_bf16_f32 v81, v82, v83
v_mfma_f32_16x16x32_bf16 v[84:87], v[248:251], v[76:79], v[84:87]
ds_write_b32 v9, v80 offset:0
v_mfma_f32_16x16x32_bf16 v[124:127], a[116:119], v[44:47], v[124:127]
ds_write_b32 v9, v81 offset:4
v_mfma_f32_16x16x32_bf16 v[124:127], a[128:131], v[48:51], v[124:127]
v_mfma_f32_16x16x32_bf16 v[124:127], a[140:143], v[52:55], v[124:127]
v_mfma_f32_16x16x32_bf16 v[124:127], a[152:155], v[56:59], v[124:127]
v_mfma_f32_16x16x32_bf16 v[124:127], a[164:167], v[60:63], v[124:127]
v_mfma_f32_16x16x32_bf16 v[124:127], a[176:179], v[64:67], v[124:127]
v_mfma_f32_16x16x32_bf16 v[124:127], a[188:191], v[68:71], v[124:127]
v_mfma_f32_16x16x32_bf16 v[124:127], a[200:203], v[72:75], v[124:127]
v_cvt_pk_bf16_f32 v84, v84, v85
v_cvt_pk_bf16_f32 v85, v86, v87
v_mfma_f32_16x16x32_bf16 v[124:127], a[212:215], v[76:79], v[124:127]
ds_write_b32 v10, v84 offset:0
v_mfma_f32_16x16x32_bf16 v[116:119], a[108:111], v[44:47], v[116:119]
ds_write_b32 v10, v85 offset:4
v_mfma_f32_16x16x32_bf16 v[116:119], a[120:123], v[48:51], v[116:119]
buffer_load_dwordx4 v7, s[12:15], s40 offen nt lds
s_add_u32 m0, s43, 8192
v_mfma_f32_16x16x32_bf16 v[116:119], a[132:135], v[52:55], v[116:119]
v_mfma_f32_16x16x32_bf16 v[116:119], a[144:147], v[56:59], v[116:119]
v_mfma_f32_16x16x32_bf16 v[116:119], a[156:159], v[60:63], v[116:119]
v_mfma_f32_16x16x32_bf16 v[116:119], a[168:171], v[64:67], v[116:119]
v_mfma_f32_16x16x32_bf16 v[116:119], a[180:183], v[68:71], v[116:119]
v_mfma_f32_16x16x32_bf16 v[116:119], a[192:195], v[72:75], v[116:119]
v_mfma_f32_16x16x32_bf16 v[116:119], a[204:207], v[76:79], v[116:119]
v_mfma_f32_16x16x32_bf16 v[120:123], a[112:115], v[44:47], v[120:123]
v_mfma_f32_16x16x32_bf16 v[120:123], a[124:127], v[48:51], v[120:123]
v_mfma_f32_16x16x32_bf16 v[120:123], a[136:139], v[52:55], v[120:123]
v_mfma_f32_16x16x32_bf16 v[120:123], a[148:151], v[56:59], v[120:123]
v_mfma_f32_16x16x32_bf16 v[120:123], a[160:163], v[60:63], v[120:123]
v_mfma_f32_16x16x32_bf16 v[120:123], a[172:175], v[64:67], v[120:123]
v_mfma_f32_16x16x32_bf16 v[120:123], a[184:187], v[68:71], v[120:123]
v_mfma_f32_16x16x32_bf16 v[120:123], a[196:199], v[72:75], v[120:123]
v_mfma_f32_16x16x32_bf16 v[120:123], a[208:211], v[76:79], v[120:123]
buffer_load_dwordx4 v8, s[12:15], s40 offen nt lds
s_add_u32 s40, s40, s41
v_mfma_f32_16x16x32_bf16 v[160:163], a[8:11], v[44:47], v[28:31]
s_add_u32 m0, s42, 53248
v_mfma_f32_16x16x32_bf16 v[160:163], a[20:23], v[48:51], v[160:163]
v_mfma_f32_16x16x32_bf16 v[160:163], a[32:35], v[52:55], v[160:163]
v_mfma_f32_16x16x32_bf16 v[160:163], a[44:47], v[56:59], v[160:163]
v_mfma_f32_16x16x32_bf16 v[160:163], a[56:59], v[60:63], v[160:163]
v_mfma_f32_16x16x32_bf16 v[160:163], a[68:71], v[64:67], v[160:163]
v_mfma_f32_16x16x32_bf16 v[160:163], a[80:83], v[68:71], v[160:163]
v_mfma_f32_16x16x32_bf16 v[160:163], a[92:95], v[72:75], v[160:163]
v_mfma_f32_16x16x32_bf16 v[160:163], a[104:107], v[76:79], v[160:163]
v_mfma_f32_16x16x32_bf16 v[152:155], a[0:3], v[44:47], v[20:23]
v_mfma_f32_16x16x32_bf16 v[152:155], a[12:15], v[48:51], v[152:155]
v_mfma_f32_16x16x32_bf16 v[152:155], a[24:27], v[52:55], v[152:155]
v_mfma_f32_16x16x32_bf16 v[152:155], a[36:39], v[56:59], v[152:155]
v_mfma_f32_16x16x32_bf16 v[152:155], a[48:51], v[60:63], v[152:155]
v_mfma_f32_16x16x32_bf16 v[152:155], a[60:63], v[64:67], v[152:155]
v_mfma_f32_16x16x32_bf16 v[152:155], a[72:75], v[68:71], v[152:155]
buffer_load_dwordx4 v4, s[12:15], s40 offen nt lds
s_add_u32 m0, s42, 55296
v_mfma_f32_16x16x32_bf16 v[152:155], a[84:87], v[72:75], v[152:155]
v_mfma_f32_16x16x32_bf16 v[152:155], a[96:99], v[76:79], v[152:155]
v_mfma_f32_16x16x32_bf16 v[156:159], a[4:7], v[44:47], v[24:27]
ds_read_b128 v[44:47], v2 offset:3072
v_mfma_f32_16x16x32_bf16 v[156:159], a[16:19], v[48:51], v[156:159]
ds_read_b128 v[48:51], v2 offset:3136
v_mfma_f32_16x16x32_bf16 v[156:159], a[28:31], v[52:55], v[156:159]
ds_read_b128 v[52:55], v2 offset:3200
v_mfma_f32_16x16x32_bf16 v[156:159], a[40:43], v[56:59], v[156:159]
ds_read_b128 v[56:59], v3 offset:3072
v_mfma_f32_16x16x32_bf16 v[156:159], a[52:55], v[60:63], v[156:159]
ds_read_b128 v[60:63], v3 offset:3136
Lstub5:
s_cbranch_execz Lstub9
v_mfma_f32_16x16x32_bf16 v[156:159], a[64:67], v[64:67], v[156:159]
ds_read_b128 v[64:67], v3 offset:3200
v_mfma_f32_16x16x32_bf16 v[156:159], a[76:79], v[68:71], v[156:159]
ds_read_b128 v[68:71], v1 offset:6144
v_mfma_f32_16x16x32_bf16 v[156:159], a[88:91], v[72:75], v[156:159]
ds_read_b128 v[72:75], v1 offset:6208
v_mfma_f32_16x16x32_bf16 v[156:159], a[100:103], v[76:79], v[156:159]
ds_read_b128 v[76:79], v1 offset:6272
v_mfma_f32_16x16x32_bf16 v[100:103], a[224:227], v[32:35], v[100:103]
v_mfma_f32_16x16x32_bf16 v[100:103], a[236:239], v[36:39], v[100:103]
v_mfma_f32_16x16x32_bf16 v[100:103], a[248:251], v[40:43], v[100:103]
s_waitcnt lgkmcnt(3)
v_mfma_f32_16x16x32_bf16 v[100:103], v[192:195], v[44:47], v[100:103]
v_mfma_f32_16x16x32_bf16 v[100:103], v[204:207], v[48:51], v[100:103]
buffer_load_dwordx4 v5, s[12:15], s40 offen nt lds
s_add_u32 m0, s42, 57344
v_mfma_f32_16x16x32_bf16 v[100:103], v[216:219], v[52:55], v[100:103]
v_mfma_f32_16x16x32_bf16 v[100:103], v[228:231], v[56:59], v[100:103]
v_mfma_f32_16x16x32_bf16 v[100:103], v[240:243], v[60:63], v[100:103]
v_mfma_f32_16x16x32_bf16 v[100:103], v[252:255], v[64:67], v[100:103]
v_mfma_f32_16x16x32_bf16 v[92:95], a[216:219], v[32:35], v[92:95]
v_mfma_f32_16x16x32_bf16 v[92:95], a[228:231], v[36:39], v[92:95]
v_mfma_f32_16x16x32_bf16 v[92:95], a[240:243], v[40:43], v[92:95]
v_mfma_f32_16x16x32_bf16 v[92:95], a[252:255], v[44:47], v[92:95]
v_mfma_f32_16x16x32_bf16 v[92:95], v[196:199], v[48:51], v[92:95]
v_mfma_f32_16x16x32_bf16 v[92:95], v[208:211], v[52:55], v[92:95]
v_mfma_f32_16x16x32_bf16 v[92:95], v[220:223], v[56:59], v[92:95]
v_mfma_f32_16x16x32_bf16 v[92:95], v[232:235], v[60:63], v[92:95]
v_cvt_pk_bf16_f32 v100, v100, v101
v_cvt_pk_bf16_f32 v101, v102, v103
v_mfma_f32_16x16x32_bf16 v[92:95], v[244:247], v[64:67], v[92:95]
ds_write_b32 v11, v100 offset:3072
v_mfma_f32_16x16x32_bf16 v[96:99], a[220:223], v[32:35], v[96:99]
ds_write_b32 v11, v101 offset:3076
v_mfma_f32_16x16x32_bf16 v[96:99], a[232:235], v[36:39], v[96:99]
v_mfma_f32_16x16x32_bf16 v[96:99], a[244:247], v[40:43], v[96:99]
buffer_load_dwordx4 v6, s[12:15], s40 offen nt lds
s_add_u32 m0, s42, 59392
v_mfma_f32_16x16x32_bf16 v[96:99], v[188:191], v[44:47], v[96:99]
v_mfma_f32_16x16x32_bf16 v[96:99], v[200:203], v[48:51], v[96:99]
v_mfma_f32_16x16x32_bf16 v[96:99], v[212:215], v[52:55], v[96:99]
v_mfma_f32_16x16x32_bf16 v[96:99], v[224:227], v[56:59], v[96:99]
v_mfma_f32_16x16x32_bf16 v[96:99], v[236:239], v[60:63], v[96:99]
v_cvt_pk_bf16_f32 v92, v92, v93
v_cvt_pk_bf16_f32 v93, v94, v95
v_mfma_f32_16x16x32_bf16 v[96:99], v[248:251], v[64:67], v[96:99]
ds_write_b32 v9, v92 offset:3072
v_mfma_f32_16x16x32_bf16 v[136:139], a[116:119], v[32:35], v[136:139]
ds_write_b32 v9, v93 offset:3076
v_mfma_f32_16x16x32_bf16 v[136:139], a[128:131], v[36:39], v[136:139]
v_mfma_f32_16x16x32_bf16 v[136:139], a[140:143], v[40:43], v[136:139]
v_mfma_f32_16x16x32_bf16 v[136:139], a[152:155], v[44:47], v[136:139]
v_mfma_f32_16x16x32_bf16 v[136:139], a[164:167], v[48:51], v[136:139]
v_mfma_f32_16x16x32_bf16 v[136:139], a[176:179], v[52:55], v[136:139]
v_mfma_f32_16x16x32_bf16 v[136:139], a[188:191], v[56:59], v[136:139]
v_mfma_f32_16x16x32_bf16 v[136:139], a[200:203], v[60:63], v[136:139]
v_cvt_pk_bf16_f32 v96, v96, v97
v_cvt_pk_bf16_f32 v97, v98, v99
v_mfma_f32_16x16x32_bf16 v[136:139], a[212:215], v[64:67], v[136:139]
ds_write_b32 v10, v96 offset:3072
v_mfma_f32_16x16x32_bf16 v[128:131], a[108:111], v[32:35], v[128:131]
ds_write_b32 v10, v97 offset:3076
v_mfma_f32_16x16x32_bf16 v[128:131], a[120:123], v[36:39], v[128:131]
buffer_load_dwordx4 v7, s[12:15], s40 offen nt lds
s_add_u32 m0, s43, 61440
v_mfma_f32_16x16x32_bf16 v[128:131], a[132:135], v[40:43], v[128:131]
v_mfma_f32_16x16x32_bf16 v[128:131], a[144:147], v[44:47], v[128:131]
v_mfma_f32_16x16x32_bf16 v[128:131], a[156:159], v[48:51], v[128:131]
v_mfma_f32_16x16x32_bf16 v[128:131], a[168:171], v[52:55], v[128:131]
v_mfma_f32_16x16x32_bf16 v[128:131], a[180:183], v[56:59], v[128:131]
v_mfma_f32_16x16x32_bf16 v[128:131], a[192:195], v[60:63], v[128:131]
v_mfma_f32_16x16x32_bf16 v[128:131], a[204:207], v[64:67], v[128:131]
v_mfma_f32_16x16x32_bf16 v[132:135], a[112:115], v[32:35], v[132:135]
v_mfma_f32_16x16x32_bf16 v[132:135], a[124:127], v[36:39], v[132:135]
v_mfma_f32_16x16x32_bf16 v[132:135], a[136:139], v[40:43], v[132:135]
v_mfma_f32_16x16x32_bf16 v[132:135], a[148:151], v[44:47], v[132:135]
v_mfma_f32_16x16x32_bf16 v[132:135], a[160:163], v[48:51], v[132:135]
v_mfma_f32_16x16x32_bf16 v[132:135], a[172:175], v[52:55], v[132:135]
v_mfma_f32_16x16x32_bf16 v[132:135], a[184:187], v[56:59], v[132:135]
v_mfma_f32_16x16x32_bf16 v[132:135], a[196:199], v[60:63], v[132:135]
v_mfma_f32_16x16x32_bf16 v[132:135], a[208:211], v[64:67], v[132:135]
buffer_load_dwordx4 v8, s[12:15], s40 offen nt lds
s_add_u32 s40, s40, s41
v_mfma_f32_16x16x32_bf16 v[172:175], a[8:11], v[32:35], v[28:31]
s_add_u32 m0, s42, 72448
v_mfma_f32_16x16x32_bf16 v[172:175], a[20:23], v[36:39], v[172:175]
v_mfma_f32_16x16x32_bf16 v[172:175], a[32:35], v[40:43], v[172:175]
v_mfma_f32_16x16x32_bf16 v[172:175], a[44:47], v[44:47], v[172:175]
v_mfma_f32_16x16x32_bf16 v[172:175], a[56:59], v[48:51], v[172:175]
v_mfma_f32_16x16x32_bf16 v[172:175], a[68:71], v[52:55], v[172:175]
v_mfma_f32_16x16x32_bf16 v[172:175], a[80:83], v[56:59], v[172:175]
v_mfma_f32_16x16x32_bf16 v[172:175], a[92:95], v[60:63], v[172:175]
v_mfma_f32_16x16x32_bf16 v[172:175], a[104:107], v[64:67], v[172:175]
v_mfma_f32_16x16x32_bf16 v[164:167], a[0:3], v[32:35], v[20:23]
v_mfma_f32_16x16x32_bf16 v[164:167], a[12:15], v[36:39], v[164:167]
v_mfma_f32_16x16x32_bf16 v[164:167], a[24:27], v[40:43], v[164:167]
v_mfma_f32_16x16x32_bf16 v[164:167], a[36:39], v[44:47], v[164:167]
v_mfma_f32_16x16x32_bf16 v[164:167], a[48:51], v[48:51], v[164:167]
v_mfma_f32_16x16x32_bf16 v[164:167], a[60:63], v[52:55], v[164:167]
v_mfma_f32_16x16x32_bf16 v[164:167], a[72:75], v[56:59], v[164:167]
buffer_load_dwordx4 v4, s[12:15], s40 offen nt lds
s_add_u32 m0, s42, 74496
v_mfma_f32_16x16x32_bf16 v[164:167], a[84:87], v[60:63], v[164:167]
v_mfma_f32_16x16x32_bf16 v[164:167], a[96:99], v[64:67], v[164:167]
v_mfma_f32_16x16x32_bf16 v[168:171], a[4:7], v[32:35], v[24:27]
ds_read_b128 v[32:35], v2 offset:6144
v_mfma_f32_16x16x32_bf16 v[168:171], a[16:19], v[36:39], v[168:171]
ds_read_b128 v[36:39], v2 offset:6208
v_mfma_f32_16x16x32_bf16 v[168:171], a[28:31], v[40:43], v[168:171]
ds_read_b128 v[40:43], v2 offset:6272
v_mfma_f32_16x16x32_bf16 v[168:171], a[40:43], v[44:47], v[168:171]
ds_read_b128 v[44:47], v3 offset:6144
v_mfma_f32_16x16x32_bf16 v[168:171], a[52:55], v[48:51], v[168:171]
ds_read_b128 v[48:51], v3 offset:6208
v_mfma_f32_16x16x32_bf16 v[168:171], a[64:67], v[52:55], v[168:171]
ds_read_b128 v[52:55], v3 offset:6272
v_add_u32 v1, 4294948096, v1
v_mfma_f32_16x16x32_bf16 v[168:171], a[76:79], v[56:59], v[168:171]
v_add_u32 v2, 4294948096, v2
v_add_u32 v3, 4294948096, v3
v_mfma_f32_16x16x32_bf16 v[168:171], a[88:91], v[60:63], v[168:171]
v_mfma_f32_16x16x32_bf16 v[168:171], a[100:103], v[64:67], v[168:171]
s_waitcnt lgkmcnt(3)
v_mfma_f32_16x16x32_bf16 v[112:115], a[224:227], v[68:71], v[112:115]
v_mfma_f32_16x16x32_bf16 v[112:115], a[236:239], v[72:75], v[112:115]
v_mfma_f32_16x16x32_bf16 v[112:115], a[248:251], v[76:79], v[112:115]
v_mfma_f32_16x16x32_bf16 v[112:115], v[192:195], v[32:35], v[112:115]
v_mfma_f32_16x16x32_bf16 v[112:115], v[204:207], v[36:39], v[112:115]
buffer_load_dwordx4 v5, s[12:15], s40 offen nt lds
Lstub6:
s_cbranch_execz Lstub10
s_add_u32 m0, s42, 76544
v_mfma_f32_16x16x32_bf16 v[112:115], v[216:219], v[40:43], v[112:115]
s_waitcnt lgkmcnt(0)
v_mfma_f32_16x16x32_bf16 v[112:115], v[228:231], v[44:47], v[112:115]
v_mfma_f32_16x16x32_bf16 v[112:115], v[240:243], v[48:51], v[112:115]
v_mfma_f32_16x16x32_bf16 v[112:115], v[252:255], v[52:55], v[112:115]
v_mfma_f32_16x16x32_bf16 v[104:107], a[216:219], v[68:71], v[104:107]
v_mfma_f32_16x16x32_bf16 v[104:107], a[228:231], v[72:75], v[104:107]
v_mfma_f32_16x16x32_bf16 v[104:107], a[240:243], v[76:79], v[104:107]
v_mfma_f32_16x16x32_bf16 v[104:107], a[252:255], v[32:35], v[104:107]
v_mfma_f32_16x16x32_bf16 v[104:107], v[196:199], v[36:39], v[104:107]
v_mfma_f32_16x16x32_bf16 v[104:107], v[208:211], v[40:43], v[104:107]
v_mfma_f32_16x16x32_bf16 v[104:107], v[220:223], v[44:47], v[104:107]
v_mfma_f32_16x16x32_bf16 v[104:107], v[232:235], v[48:51], v[104:107]
v_cvt_pk_bf16_f32 v112, v112, v113
v_cvt_pk_bf16_f32 v113, v114, v115
v_mfma_f32_16x16x32_bf16 v[104:107], v[244:247], v[52:55], v[104:107]
ds_write_b32 v11, v112 offset:6144
v_mfma_f32_16x16x32_bf16 v[108:111], a[220:223], v[68:71], v[108:111]
ds_write_b32 v11, v113 offset:6148
v_mfma_f32_16x16x32_bf16 v[108:111], a[232:235], v[72:75], v[108:111]
v_mfma_f32_16x16x32_bf16 v[108:111], a[244:247], v[76:79], v[108:111]
buffer_load_dwordx4 v6, s[12:15], s40 offen nt lds
s_add_u32 m0, s42, 78592
v_mfma_f32_16x16x32_bf16 v[108:111], v[188:191], v[32:35], v[108:111]
v_mfma_f32_16x16x32_bf16 v[108:111], v[200:203], v[36:39], v[108:111]
v_mfma_f32_16x16x32_bf16 v[108:111], v[212:215], v[40:43], v[108:111]
v_mfma_f32_16x16x32_bf16 v[108:111], v[224:227], v[44:47], v[108:111]
v_mfma_f32_16x16x32_bf16 v[108:111], v[236:239], v[48:51], v[108:111]
v_cvt_pk_bf16_f32 v104, v104, v105
v_cvt_pk_bf16_f32 v105, v106, v107
v_mfma_f32_16x16x32_bf16 v[108:111], v[248:251], v[52:55], v[108:111]
ds_write_b32 v9, v104 offset:6144
v_mfma_f32_16x16x32_bf16 v[148:151], a[116:119], v[68:71], v[148:151]
ds_write_b32 v9, v105 offset:6148
v_mfma_f32_16x16x32_bf16 v[148:151], a[128:131], v[72:75], v[148:151]
v_mfma_f32_16x16x32_bf16 v[148:151], a[140:143], v[76:79], v[148:151]
v_mfma_f32_16x16x32_bf16 v[148:151], a[152:155], v[32:35], v[148:151]
v_mfma_f32_16x16x32_bf16 v[148:151], a[164:167], v[36:39], v[148:151]
v_mfma_f32_16x16x32_bf16 v[148:151], a[176:179], v[40:43], v[148:151]
v_mfma_f32_16x16x32_bf16 v[148:151], a[188:191], v[44:47], v[148:151]
v_mfma_f32_16x16x32_bf16 v[148:151], a[200:203], v[48:51], v[148:151]
v_cvt_pk_bf16_f32 v108, v108, v109
v_cvt_pk_bf16_f32 v109, v110, v111
v_mfma_f32_16x16x32_bf16 v[148:151], a[212:215], v[52:55], v[148:151]
ds_write_b32 v10, v108 offset:6144
v_mfma_f32_16x16x32_bf16 v[140:143], a[108:111], v[68:71], v[140:143]
ds_write_b32 v10, v109 offset:6148
v_mfma_f32_16x16x32_bf16 v[140:143], a[120:123], v[72:75], v[140:143]
buffer_load_dwordx4 v7, s[12:15], s40 offen nt lds
v_add_u32 v9, 4294856448, v9
v_mfma_f32_16x16x32_bf16 v[140:143], a[132:135], v[76:79], v[140:143]
s_add_u32 m0, s43, 80640
v_add_u32 v10, 4294856448, v10
v_add_u32 v11, 4294856448, v11
v_mfma_f32_16x16x32_bf16 v[140:143], a[144:147], v[32:35], v[140:143]
v_mfma_f32_16x16x32_bf16 v[140:143], a[156:159], v[36:39], v[140:143]
v_mfma_f32_16x16x32_bf16 v[140:143], a[168:171], v[40:43], v[140:143]
v_mfma_f32_16x16x32_bf16 v[140:143], a[180:183], v[44:47], v[140:143]
v_mfma_f32_16x16x32_bf16 v[140:143], a[192:195], v[48:51], v[140:143]
v_mfma_f32_16x16x32_bf16 v[140:143], a[204:207], v[52:55], v[140:143]
v_mfma_f32_16x16x32_bf16 v[144:147], a[112:115], v[68:71], v[144:147]
v_mfma_f32_16x16x32_bf16 v[144:147], a[124:127], v[72:75], v[144:147]
v_mfma_f32_16x16x32_bf16 v[144:147], a[136:139], v[76:79], v[144:147]
v_mfma_f32_16x16x32_bf16 v[144:147], a[148:151], v[32:35], v[144:147]
v_mfma_f32_16x16x32_bf16 v[144:147], a[160:163], v[36:39], v[144:147]
v_mfma_f32_16x16x32_bf16 v[144:147], a[172:175], v[40:43], v[144:147]
v_mfma_f32_16x16x32_bf16 v[144:147], a[184:187], v[44:47], v[144:147]
v_mfma_f32_16x16x32_bf16 v[144:147], a[196:199], v[48:51], v[144:147]
v_mfma_f32_16x16x32_bf16 v[144:147], a[208:211], v[52:55], v[144:147]
buffer_load_dwordx4 v8, s[12:15], s40 offen nt lds
s_add_u32 s40, s40, s41
v_mfma_f32_16x16x32_bf16 v[184:187], a[8:11], v[68:71], v[28:31]
s_add_u32 m0, s42, 91648
v_mfma_f32_16x16x32_bf16 v[184:187], a[20:23], v[72:75], v[184:187]
v_mfma_f32_16x16x32_bf16 v[184:187], a[32:35], v[76:79], v[184:187]
v_mfma_f32_16x16x32_bf16 v[184:187], a[44:47], v[32:35], v[184:187]
v_mfma_f32_16x16x32_bf16 v[184:187], a[56:59], v[36:39], v[184:187]
v_mfma_f32_16x16x32_bf16 v[184:187], a[68:71], v[40:43], v[184:187]
v_mfma_f32_16x16x32_bf16 v[184:187], a[80:83], v[44:47], v[184:187]
v_mfma_f32_16x16x32_bf16 v[184:187], a[92:95], v[48:51], v[184:187]
v_mfma_f32_16x16x32_bf16 v[184:187], a[104:107], v[52:55], v[184:187]
v_mfma_f32_16x16x32_bf16 v[176:179], a[0:3], v[68:71], v[20:23]
v_mfma_f32_16x16x32_bf16 v[176:179], a[12:15], v[72:75], v[176:179]
v_mfma_f32_16x16x32_bf16 v[176:179], a[24:27], v[76:79], v[176:179]
s_waitcnt vmcnt(10) lgkmcnt(0)
s_barrier
v_mfma_f32_16x16x32_bf16 v[176:179], a[36:39], v[32:35], v[176:179]
ds_read_b128 v[56:59], v1 offset:0
v_mfma_f32_16x16x32_bf16 v[176:179], a[48:51], v[36:39], v[176:179]
ds_read_b128 v[60:63], v1 offset:64
v_mfma_f32_16x16x32_bf16 v[176:179], a[60:63], v[40:43], v[176:179]
ds_read_b128 v[64:67], v1 offset:128
v_mfma_f32_16x16x32_bf16 v[176:179], a[72:75], v[44:47], v[176:179]
buffer_load_dwordx4 v4, s[12:15], s40 offen nt lds
s_add_u32 m0, s42, 93696
v_mfma_f32_16x16x32_bf16 v[176:179], a[84:87], v[48:51], v[176:179]
v_mfma_f32_16x16x32_bf16 v[176:179], a[96:99], v[52:55], v[176:179]
v_mfma_f32_16x16x32_bf16 v[180:183], a[4:7], v[68:71], v[24:27]
ds_read_b128 v[68:71], v2 offset:0
v_mfma_f32_16x16x32_bf16 v[180:183], a[16:19], v[72:75], v[180:183]
ds_read_b128 v[72:75], v2 offset:64
v_mfma_f32_16x16x32_bf16 v[180:183], a[28:31], v[76:79], v[180:183]
ds_read_b128 v[76:79], v2 offset:128
v_mfma_f32_16x16x32_bf16 v[180:183], a[40:43], v[32:35], v[180:183]
ds_read_b128 v[32:35], v3 offset:0
v_mfma_f32_16x16x32_bf16 v[180:183], a[52:55], v[36:39], v[180:183]
ds_read_b128 v[36:39], v3 offset:64
v_mfma_f32_16x16x32_bf16 v[180:183], a[64:67], v[40:43], v[180:183]
ds_read_b128 v[40:43], v3 offset:128
v_mfma_f32_16x16x32_bf16 v[180:183], a[76:79], v[44:47], v[180:183]
ds_read_b128 v[44:47], v1 offset:3072
v_mfma_f32_16x16x32_bf16 v[180:183], a[88:91], v[48:51], v[180:183]
ds_read_b128 v[48:51], v1 offset:3136
v_mfma_f32_16x16x32_bf16 v[180:183], a[100:103], v[52:55], v[180:183]
ds_read_b128 v[52:55], v1 offset:3200
s_waitcnt lgkmcnt(6)
v_mfma_f32_16x16x32_bf16 v[124:127], a[224:227], v[56:59], v[124:127]
v_mfma_f32_16x16x32_bf16 v[124:127], a[236:239], v[60:63], v[124:127]
v_mfma_f32_16x16x32_bf16 v[124:127], a[248:251], v[64:67], v[124:127]
v_mfma_f32_16x16x32_bf16 v[124:127], v[192:195], v[68:71], v[124:127]
v_mfma_f32_16x16x32_bf16 v[124:127], v[204:207], v[72:75], v[124:127]
buffer_load_dwordx4 v5, s[12:15], s40 offen nt lds
s_add_u32 m0, s42, 95744
v_mfma_f32_16x16x32_bf16 v[124:127], v[216:219], v[76:79], v[124:127]
s_waitcnt lgkmcnt(0)
v_mfma_f32_16x16x32_bf16 v[124:127], v[228:231], v[32:35], v[124:127]
v_mfma_f32_16x16x32_bf16 v[124:127], v[240:243], v[36:39], v[124:127]
v_mfma_f32_16x16x32_bf16 v[124:127], v[252:255], v[40:43], v[124:127]
v_mfma_f32_16x16x32_bf16 v[116:119], a[216:219], v[56:59], v[116:119]
Lstub7:
s_cbranch_execz Lstub11
v_mfma_f32_16x16x32_bf16 v[116:119], a[228:231], v[60:63], v[116:119]
v_mfma_f32_16x16x32_bf16 v[116:119], a[240:243], v[64:67], v[116:119]
v_mfma_f32_16x16x32_bf16 v[116:119], a[252:255], v[68:71], v[116:119]
v_mfma_f32_16x16x32_bf16 v[116:119], v[196:199], v[72:75], v[116:119]
v_mfma_f32_16x16x32_bf16 v[116:119], v[208:211], v[76:79], v[116:119]
v_mfma_f32_16x16x32_bf16 v[116:119], v[220:223], v[32:35], v[116:119]
v_mfma_f32_16x16x32_bf16 v[116:119], v[232:235], v[36:39], v[116:119]
v_cvt_pk_bf16_f32 v124, v124, v125
v_cvt_pk_bf16_f32 v125, v126, v127
v_mfma_f32_16x16x32_bf16 v[116:119], v[244:247], v[40:43], v[116:119]
ds_write_b32 v11, v124 offset:0
v_mfma_f32_16x16x32_bf16 v[120:123], a[220:223], v[56:59], v[120:123]
ds_write_b32 v11, v125 offset:4
v_mfma_f32_16x16x32_bf16 v[120:123], a[232:235], v[60:63], v[120:123]
v_mfma_f32_16x16x32_bf16 v[120:123], a[244:247], v[64:67], v[120:123]
buffer_load_dwordx4 v6, s[12:15], s40 offen nt lds
s_add_u32 m0, s42, 97792
v_mfma_f32_16x16x32_bf16 v[120:123], v[188:191], v[68:71], v[120:123]
v_mfma_f32_16x16x32_bf16 v[120:123], v[200:203], v[72:75], v[120:123]
v_mfma_f32_16x16x32_bf16 v[120:123], v[212:215], v[76:79], v[120:123]
v_mfma_f32_16x16x32_bf16 v[120:123], v[224:227], v[32:35], v[120:123]
v_mfma_f32_16x16x32_bf16 v[120:123], v[236:239], v[36:39], v[120:123]
v_cvt_pk_bf16_f32 v116, v116, v117
v_cvt_pk_bf16_f32 v117, v118, v119
v_mfma_f32_16x16x32_bf16 v[120:123], v[248:251], v[40:43], v[120:123]
ds_write_b32 v9, v116 offset:0
v_mfma_f32_16x16x32_bf16 v[160:163], a[116:119], v[56:59], v[160:163]
ds_write_b32 v9, v117 offset:4
v_mfma_f32_16x16x32_bf16 v[160:163], a[128:131], v[60:63], v[160:163]
v_mfma_f32_16x16x32_bf16 v[160:163], a[140:143], v[64:67], v[160:163]
v_mfma_f32_16x16x32_bf16 v[160:163], a[152:155], v[68:71], v[160:163]
v_mfma_f32_16x16x32_bf16 v[160:163], a[164:167], v[72:75], v[160:163]
v_mfma_f32_16x16x32_bf16 v[160:163], a[176:179], v[76:79], v[160:163]
v_mfma_f32_16x16x32_bf16 v[160:163], a[188:191], v[32:35], v[160:163]
v_mfma_f32_16x16x32_bf16 v[160:163], a[200:203], v[36:39], v[160:163]
v_cvt_pk_bf16_f32 v120, v120, v121
v_cvt_pk_bf16_f32 v121, v122, v123
v_mfma_f32_16x16x32_bf16 v[160:163], a[212:215], v[40:43], v[160:163]
ds_write_b32 v10, v120 offset:0
v_mfma_f32_16x16x32_bf16 v[152:155], a[108:111], v[56:59], v[152:155]
ds_write_b32 v10, v121 offset:4
v_mfma_f32_16x16x32_bf16 v[152:155], a[120:123], v[60:63], v[152:155]
buffer_load_dwordx4 v7, s[12:15], s40 offen nt lds
s_add_u32 m0, s43, 99840
v_mfma_f32_16x16x32_bf16 v[152:155], a[132:135], v[64:67], v[152:155]
v_mfma_f32_16x16x32_bf16 v[152:155], a[144:147], v[68:71], v[152:155]
v_mfma_f32_16x16x32_bf16 v[152:155], a[156:159], v[72:75], v[152:155]
v_mfma_f32_16x16x32_bf16 v[152:155], a[168:171], v[76:79], v[152:155]
v_mfma_f32_16x16x32_bf16 v[152:155], a[180:183], v[32:35], v[152:155]
v_mfma_f32_16x16x32_bf16 v[152:155], a[192:195], v[36:39], v[152:155]
v_mfma_f32_16x16x32_bf16 v[152:155], a[204:207], v[40:43], v[152:155]
v_mfma_f32_16x16x32_bf16 v[156:159], a[112:115], v[56:59], v[156:159]
v_mfma_f32_16x16x32_bf16 v[156:159], a[124:127], v[60:63], v[156:159]
v_mfma_f32_16x16x32_bf16 v[156:159], a[136:139], v[64:67], v[156:159]
v_mfma_f32_16x16x32_bf16 v[156:159], a[148:151], v[68:71], v[156:159]
v_mfma_f32_16x16x32_bf16 v[156:159], a[160:163], v[72:75], v[156:159]
v_mfma_f32_16x16x32_bf16 v[156:159], a[172:175], v[76:79], v[156:159]
v_mfma_f32_16x16x32_bf16 v[156:159], a[184:187], v[32:35], v[156:159]
v_mfma_f32_16x16x32_bf16 v[156:159], a[196:199], v[36:39], v[156:159]
v_mfma_f32_16x16x32_bf16 v[156:159], a[208:211], v[40:43], v[156:159]
buffer_load_dwordx4 v8, s[12:15], s40 offen nt lds
s_add_u32 m0, s42, 110848
v_mfma_f32_16x16x32_bf16 v[88:91], a[8:11], v[56:59], v[28:31]
v_mfma_f32_16x16x32_bf16 v[88:91], a[20:23], v[60:63], v[88:91]
v_mfma_f32_16x16x32_bf16 v[88:91], a[32:35], v[64:67], v[88:91]
v_mfma_f32_16x16x32_bf16 v[88:91], a[44:47], v[68:71], v[88:91]
v_mfma_f32_16x16x32_bf16 v[88:91], a[56:59], v[72:75], v[88:91]
v_mfma_f32_16x16x32_bf16 v[88:91], a[68:71], v[76:79], v[88:91]
v_mfma_f32_16x16x32_bf16 v[88:91], a[80:83], v[32:35], v[88:91]
v_mfma_f32_16x16x32_bf16 v[88:91], a[92:95], v[36:39], v[88:91]
v_mfma_f32_16x16x32_bf16 v[88:91], a[104:107], v[40:43], v[88:91]
v_mfma_f32_16x16x32_bf16 v[80:83], a[0:3], v[56:59], v[20:23]
v_mfma_f32_16x16x32_bf16 v[80:83], a[12:15], v[60:63], v[80:83]
v_mfma_f32_16x16x32_bf16 v[80:83], a[24:27], v[64:67], v[80:83]
v_mfma_f32_16x16x32_bf16 v[80:83], a[36:39], v[68:71], v[80:83]
v_mfma_f32_16x16x32_bf16 v[80:83], a[48:51], v[72:75], v[80:83]
v_mfma_f32_16x16x32_bf16 v[80:83], a[60:63], v[76:79], v[80:83]
v_mfma_f32_16x16x32_bf16 v[80:83], a[72:75], v[32:35], v[80:83]
buffer_load_dwordx4 v4, s[36:39], s58 offen nt lds
s_add_u32 m0, s42, 112896
v_mfma_f32_16x16x32_bf16 v[80:83], a[84:87], v[36:39], v[80:83]
v_mfma_f32_16x16x32_bf16 v[80:83], a[96:99], v[40:43], v[80:83]
v_mfma_f32_16x16x32_bf16 v[84:87], a[4:7], v[56:59], v[24:27]
ds_read_b128 v[56:59], v2 offset:3072
v_mfma_f32_16x16x32_bf16 v[84:87], a[16:19], v[60:63], v[84:87]
ds_read_b128 v[60:63], v2 offset:3136
v_mfma_f32_16x16x32_bf16 v[84:87], a[28:31], v[64:67], v[84:87]
ds_read_b128 v[64:67], v2 offset:3200
v_mfma_f32_16x16x32_bf16 v[84:87], a[40:43], v[68:71], v[84:87]
ds_read_b128 v[68:71], v3 offset:3072
v_mfma_f32_16x16x32_bf16 v[84:87], a[52:55], v[72:75], v[84:87]
ds_read_b128 v[72:75], v3 offset:3136
v_mfma_f32_16x16x32_bf16 v[84:87], a[64:67], v[76:79], v[84:87]
ds_read_b128 v[76:79], v3 offset:3200
v_mfma_f32_16x16x32_bf16 v[84:87], a[76:79], v[32:35], v[84:87]
ds_read_b128 v[32:35], v1 offset:6144
v_mfma_f32_16x16x32_bf16 v[84:87], a[88:91], v[36:39], v[84:87]
ds_read_b128 v[36:39], v1 offset:6208
v_mfma_f32_16x16x32_bf16 v[84:87], a[100:103], v[40:43], v[84:87]
ds_read_b128 v[40:43], v1 offset:6272
v_mfma_f32_16x16x32_bf16 v[136:139], a[224:227], v[44:47], v[136:139]
v_mfma_f32_16x16x32_bf16 v[136:139], a[236:239], v[48:51], v[136:139]
v_mfma_f32_16x16x32_bf16 v[136:139], a[248:251], v[52:55], v[136:139]
s_waitcnt lgkmcnt(3)
v_mfma_f32_16x16x32_bf16 v[136:139], v[192:195], v[56:59], v[136:139]
v_mfma_f32_16x16x32_bf16 v[136:139], v[204:207], v[60:63], v[136:139]
buffer_load_dwordx4 v5, s[36:39], s58 offen nt lds
s_add_u32 m0, s42, 114944
v_mfma_f32_16x16x32_bf16 v[136:139], v[216:219], v[64:67], v[136:139]
v_mfma_f32_16x16x32_bf16 v[136:139], v[228:231], v[68:71], v[136:139]
v_mfma_f32_16x16x32_bf16 v[136:139], v[240:243], v[72:75], v[136:139]
v_mfma_f32_16x16x32_bf16 v[136:139], v[252:255], v[76:79], v[136:139]
v_mfma_f32_16x16x32_bf16 v[128:131], a[216:219], v[44:47], v[128:131]
v_mfma_f32_16x16x32_bf16 v[128:131], a[228:231], v[48:51], v[128:131]
v_mfma_f32_16x16x32_bf16 v[128:131], a[240:243], v[52:55], v[128:131]
v_mfma_f32_16x16x32_bf16 v[128:131], a[252:255], v[56:59], v[128:131]
v_mfma_f32_16x16x32_bf16 v[128:131], v[196:199], v[60:63], v[128:131]
v_mfma_f32_16x16x32_bf16 v[128:131], v[208:211], v[64:67], v[128:131]
v_mfma_f32_16x16x32_bf16 v[128:131], v[220:223], v[68:71], v[128:131]
v_mfma_f32_16x16x32_bf16 v[128:131], v[232:235], v[72:75], v[128:131]
v_cvt_pk_bf16_f32 v136, v136, v137
v_cvt_pk_bf16_f32 v137, v138, v139
v_mfma_f32_16x16x32_bf16 v[128:131], v[244:247], v[76:79], v[128:131]
ds_write_b32 v11, v136 offset:3072
v_mfma_f32_16x16x32_bf16 v[132:135], a[220:223], v[44:47], v[132:135]
ds_write_b32 v11, v137 offset:3076
v_mfma_f32_16x16x32_bf16 v[132:135], a[232:235], v[48:51], v[132:135]
v_mfma_f32_16x16x32_bf16 v[132:135], a[244:247], v[52:55], v[132:135]
Lstub8:
s_cbranch_execz Lstub12
buffer_load_dwordx4 v6, s[36:39], s58 offen nt lds
s_add_u32 m0, s42, 116992
v_mfma_f32_16x16x32_bf16 v[132:135], v[188:191], v[56:59], v[132:135]
v_mfma_f32_16x16x32_bf16 v[132:135], v[200:203], v[60:63], v[132:135]
v_mfma_f32_16x16x32_bf16 v[132:135], v[212:215], v[64:67], v[132:135]
v_mfma_f32_16x16x32_bf16 v[132:135], v[224:227], v[68:71], v[132:135]
v_mfma_f32_16x16x32_bf16 v[132:135], v[236:239], v[72:75], v[132:135]
v_cvt_pk_bf16_f32 v128, v128, v129
v_cvt_pk_bf16_f32 v129, v130, v131
v_mfma_f32_16x16x32_bf16 v[132:135], v[248:251], v[76:79], v[132:135]
ds_write_b32 v9, v128 offset:3072
v_mfma_f32_16x16x32_bf16 v[172:175], a[116:119], v[44:47], v[172:175]
ds_write_b32 v9, v129 offset:3076
v_mfma_f32_16x16x32_bf16 v[172:175], a[128:131], v[48:51], v[172:175]
v_mfma_f32_16x16x32_bf16 v[172:175], a[140:143], v[52:55], v[172:175]
v_mfma_f32_16x16x32_bf16 v[172:175], a[152:155], v[56:59], v[172:175]
v_mfma_f32_16x16x32_bf16 v[172:175], a[164:167], v[60:63], v[172:175]
v_mfma_f32_16x16x32_bf16 v[172:175], a[176:179], v[64:67], v[172:175]
v_mfma_f32_16x16x32_bf16 v[172:175], a[188:191], v[68:71], v[172:175]
v_mfma_f32_16x16x32_bf16 v[172:175], a[200:203], v[72:75], v[172:175]
v_cvt_pk_bf16_f32 v132, v132, v133
v_cvt_pk_bf16_f32 v133, v134, v135
v_mfma_f32_16x16x32_bf16 v[172:175], a[212:215], v[76:79], v[172:175]
ds_write_b32 v10, v132 offset:3072
v_mfma_f32_16x16x32_bf16 v[164:167], a[108:111], v[44:47], v[164:167]
ds_write_b32 v10, v133 offset:3076
v_mfma_f32_16x16x32_bf16 v[164:167], a[120:123], v[48:51], v[164:167]
buffer_load_dwordx4 v7, s[36:39], s58 offen nt lds
s_add_u32 m0, s43, 119040
v_mfma_f32_16x16x32_bf16 v[164:167], a[132:135], v[52:55], v[164:167]
v_mfma_f32_16x16x32_bf16 v[164:167], a[144:147], v[56:59], v[164:167]
v_mfma_f32_16x16x32_bf16 v[164:167], a[156:159], v[60:63], v[164:167]
v_mfma_f32_16x16x32_bf16 v[164:167], a[168:171], v[64:67], v[164:167]
v_mfma_f32_16x16x32_bf16 v[164:167], a[180:183], v[68:71], v[164:167]
v_mfma_f32_16x16x32_bf16 v[164:167], a[192:195], v[72:75], v[164:167]
v_mfma_f32_16x16x32_bf16 v[164:167], a[204:207], v[76:79], v[164:167]
v_mfma_f32_16x16x32_bf16 v[168:171], a[112:115], v[44:47], v[168:171]
v_mfma_f32_16x16x32_bf16 v[168:171], a[124:127], v[48:51], v[168:171]
v_mfma_f32_16x16x32_bf16 v[168:171], a[136:139], v[52:55], v[168:171]
v_mfma_f32_16x16x32_bf16 v[168:171], a[148:151], v[56:59], v[168:171]
v_mfma_f32_16x16x32_bf16 v[168:171], a[160:163], v[60:63], v[168:171]
v_mfma_f32_16x16x32_bf16 v[168:171], a[172:175], v[64:67], v[168:171]
v_mfma_f32_16x16x32_bf16 v[168:171], a[184:187], v[68:71], v[168:171]
v_mfma_f32_16x16x32_bf16 v[168:171], a[196:199], v[72:75], v[168:171]
v_mfma_f32_16x16x32_bf16 v[168:171], a[208:211], v[76:79], v[168:171]
buffer_load_dwordx4 v8, s[36:39], s58 offen nt lds
v_mfma_f32_16x16x32_bf16 v[100:103], a[8:11], v[44:47], v[28:31]
v_mfma_f32_16x16x32_bf16 v[100:103], a[20:23], v[48:51], v[100:103]
v_mfma_f32_16x16x32_bf16 v[100:103], a[32:35], v[52:55], v[100:103]
v_mfma_f32_16x16x32_bf16 v[100:103], a[44:47], v[56:59], v[100:103]
v_mfma_f32_16x16x32_bf16 v[100:103], a[56:59], v[60:63], v[100:103]
v_mfma_f32_16x16x32_bf16 v[100:103], a[68:71], v[64:67], v[100:103]
v_mfma_f32_16x16x32_bf16 v[100:103], a[80:83], v[68:71], v[100:103]
v_mfma_f32_16x16x32_bf16 v[100:103], a[92:95], v[72:75], v[100:103]
v_mfma_f32_16x16x32_bf16 v[100:103], a[104:107], v[76:79], v[100:103]
v_mfma_f32_16x16x32_bf16 v[92:95], a[0:3], v[44:47], v[20:23]
v_mfma_f32_16x16x32_bf16 v[92:95], a[12:15], v[48:51], v[92:95]
v_mfma_f32_16x16x32_bf16 v[92:95], a[24:27], v[52:55], v[92:95]
v_mfma_f32_16x16x32_bf16 v[92:95], a[36:39], v[56:59], v[92:95]
v_mfma_f32_16x16x32_bf16 v[92:95], a[48:51], v[60:63], v[92:95]
v_mfma_f32_16x16x32_bf16 v[92:95], a[60:63], v[64:67], v[92:95]
v_mfma_f32_16x16x32_bf16 v[92:95], a[72:75], v[68:71], v[92:95]
v_mfma_f32_16x16x32_bf16 v[92:95], a[84:87], v[72:75], v[92:95]
v_mfma_f32_16x16x32_bf16 v[92:95], a[96:99], v[76:79], v[92:95]
v_mfma_f32_16x16x32_bf16 v[96:99], a[4:7], v[44:47], v[24:27]
ds_read_b128 v[44:47], v2 offset:6144
v_mfma_f32_16x16x32_bf16 v[96:99], a[16:19], v[48:51], v[96:99]
ds_read_b128 v[48:51], v2 offset:6208
v_mfma_f32_16x16x32_bf16 v[96:99], a[28:31], v[52:55], v[96:99]
ds_read_b128 v[52:55], v2 offset:6272
v_mfma_f32_16x16x32_bf16 v[96:99], a[40:43], v[56:59], v[96:99]
ds_read_b128 v[56:59], v3 offset:6144
v_mfma_f32_16x16x32_bf16 v[96:99], a[52:55], v[60:63], v[96:99]
ds_read_b128 v[60:63], v3 offset:6208
v_mfma_f32_16x16x32_bf16 v[96:99], a[64:67], v[64:67], v[96:99]
ds_read_b128 v[64:67], v3 offset:6272
v_mfma_f32_16x16x32_bf16 v[96:99], a[76:79], v[68:71], v[96:99]
v_mfma_f32_16x16x32_bf16 v[96:99], a[88:91], v[72:75], v[96:99]
v_mfma_f32_16x16x32_bf16 v[96:99], a[100:103], v[76:79], v[96:99]
s_waitcnt lgkmcnt(3)
v_mfma_f32_16x16x32_bf16 v[148:151], a[224:227], v[32:35], v[148:151]
v_mfma_f32_16x16x32_bf16 v[148:151], a[236:239], v[36:39], v[148:151]
v_mfma_f32_16x16x32_bf16 v[148:151], a[248:251], v[40:43], v[148:151]
v_mfma_f32_16x16x32_bf16 v[148:151], v[192:195], v[44:47], v[148:151]
v_mfma_f32_16x16x32_bf16 v[148:151], v[204:207], v[48:51], v[148:151]
v_mfma_f32_16x16x32_bf16 v[148:151], v[216:219], v[52:55], v[148:151]
s_waitcnt lgkmcnt(0)
v_mfma_f32_16x16x32_bf16 v[148:151], v[228:231], v[56:59], v[148:151]
v_mfma_f32_16x16x32_bf16 v[148:151], v[240:243], v[60:63], v[148:151]
v_mfma_f32_16x16x32_bf16 v[148:151], v[252:255], v[64:67], v[148:151]
v_mfma_f32_16x16x32_bf16 v[140:143], a[216:219], v[32:35], v[140:143]
v_mfma_f32_16x16x32_bf16 v[140:143], a[228:231], v[36:39], v[140:143]
v_mfma_f32_16x16x32_bf16 v[140:143], a[240:243], v[40:43], v[140:143]
v_mfma_f32_16x16x32_bf16 v[140:143], a[252:255], v[44:47], v[140:143]
v_mfma_f32_16x16x32_bf16 v[140:143], v[196:199], v[48:51], v[140:143]
v_mfma_f32_16x16x32_bf16 v[140:143], v[208:211], v[52:55], v[140:143]
v_mfma_f32_16x16x32_bf16 v[140:143], v[220:223], v[56:59], v[140:143]
v_mfma_f32_16x16x32_bf16 v[140:143], v[232:235], v[60:63], v[140:143]
v_cvt_pk_bf16_f32 v148, v148, v149
v_cvt_pk_bf16_f32 v149, v150, v151
v_mfma_f32_16x16x32_bf16 v[140:143], v[244:247], v[64:67], v[140:143]
ds_write_b32 v11, v148 offset:6144
v_mfma_f32_16x16x32_bf16 v[144:147], a[220:223], v[32:35], v[144:147]
ds_write_b32 v11, v149 offset:6148
v_mfma_f32_16x16x32_bf16 v[144:147], a[232:235], v[36:39], v[144:147]
v_mfma_f32_16x16x32_bf16 v[144:147], a[244:247], v[40:43], v[144:147]
v_mfma_f32_16x16x32_bf16 v[144:147], v[188:191], v[44:47], v[144:147]
v_mfma_f32_16x16x32_bf16 v[144:147], v[200:203], v[48:51], v[144:147]
v_mfma_f32_16x16x32_bf16 v[144:147], v[212:215], v[52:55], v[144:147]
v_mfma_f32_16x16x32_bf16 v[144:147], v[224:227], v[56:59], v[144:147]
v_mfma_f32_16x16x32_bf16 v[144:147], v[236:239], v[60:63], v[144:147]
v_cvt_pk_bf16_f32 v140, v140, v141
v_cvt_pk_bf16_f32 v141, v142, v143
v_mfma_f32_16x16x32_bf16 v[144:147], v[248:251], v[64:67], v[144:147]
ds_write_b32 v9, v140 offset:6144
v_mfma_f32_16x16x32_bf16 v[184:187], a[116:119], v[32:35], v[184:187]
ds_write_b32 v9, v141 offset:6148
v_mfma_f32_16x16x32_bf16 v[184:187], a[128:131], v[36:39], v[184:187]
v_mfma_f32_16x16x32_bf16 v[184:187], a[140:143], v[40:43], v[184:187]
v_mfma_f32_16x16x32_bf16 v[184:187], a[152:155], v[44:47], v[184:187]
v_mfma_f32_16x16x32_bf16 v[184:187], a[164:167], v[48:51], v[184:187]
ds_read_b128 v[116:119], v12 offset:0
v_mfma_f32_16x16x32_bf16 v[184:187], a[176:179], v[52:55], v[184:187]
ds_read_b128 v[120:123], v12 offset:1024
v_mfma_f32_16x16x32_bf16 v[184:187], a[188:191], v[56:59], v[184:187]
v_mfma_f32_16x16x32_bf16 v[184:187], a[200:203], v[60:63], v[184:187]
v_cvt_pk_bf16_f32 v144, v144, v145
v_cvt_pk_bf16_f32 v145, v146, v147
v_mfma_f32_16x16x32_bf16 v[184:187], a[212:215], v[64:67], v[184:187]
Lstub9:
s_cbranch_execz Lstub13
ds_write_b32 v10, v144 offset:6144
v_mfma_f32_16x16x32_bf16 v[176:179], a[108:111], v[32:35], v[176:179]
ds_write_b32 v10, v145 offset:6148
v_mfma_f32_16x16x32_bf16 v[176:179], a[120:123], v[36:39], v[176:179]
v_add_u32 v9, 4294948096, v9
v_add_u32 v10, 4294948096, v10
v_mfma_f32_16x16x32_bf16 v[176:179], a[132:135], v[40:43], v[176:179]
v_add_u32 v11, 4294948096, v11
v_mfma_f32_16x16x32_bf16 v[176:179], a[144:147], v[44:47], v[176:179]
s_waitcnt lgkmcnt(3)
v_mfma_f32_16x16x32_bf16 v[176:179], a[156:159], v[48:51], v[176:179]
buffer_store_dwordx4 v[116:119], v13, s[20:23], s57 offen offset:0 sc1
v_mfma_f32_16x16x32_bf16 v[176:179], a[168:171], v[52:55], v[176:179]
ds_read_b128 v[116:119], v12 offset:2048
v_mfma_f32_16x16x32_bf16 v[176:179], a[180:183], v[56:59], v[176:179]
v_mfma_f32_16x16x32_bf16 v[176:179], a[192:195], v[60:63], v[176:179]
v_mfma_f32_16x16x32_bf16 v[176:179], a[204:207], v[64:67], v[176:179]
v_mfma_f32_16x16x32_bf16 v[180:183], a[112:115], v[32:35], v[180:183]
v_mfma_f32_16x16x32_bf16 v[180:183], a[124:127], v[36:39], v[180:183]
v_mfma_f32_16x16x32_bf16 v[180:183], a[136:139], v[40:43], v[180:183]
v_mfma_f32_16x16x32_bf16 v[180:183], a[148:151], v[44:47], v[180:183]
v_mfma_f32_16x16x32_bf16 v[180:183], a[160:163], v[48:51], v[180:183]
v_mfma_f32_16x16x32_bf16 v[180:183], a[172:175], v[52:55], v[180:183]
v_mfma_f32_16x16x32_bf16 v[180:183], a[184:187], v[56:59], v[180:183]
v_mfma_f32_16x16x32_bf16 v[180:183], a[196:199], v[60:63], v[180:183]
v_mfma_f32_16x16x32_bf16 v[180:183], a[208:211], v[64:67], v[180:183]
v_mfma_f32_16x16x32_bf16 v[112:115], a[8:11], v[32:35], v[28:31]
v_mfma_f32_16x16x32_bf16 v[112:115], a[20:23], v[36:39], v[112:115]
v_mfma_f32_16x16x32_bf16 v[112:115], a[32:35], v[40:43], v[112:115]
s_waitcnt lgkmcnt(3)
v_mfma_f32_16x16x32_bf16 v[112:115], a[44:47], v[44:47], v[112:115]
buffer_store_dwordx4 v[120:123], v14, s[20:23], s57 offen offset:1024 sc1
v_mfma_f32_16x16x32_bf16 v[112:115], a[56:59], v[48:51], v[112:115]
ds_read_b128 v[120:123], v12 offset:3072
v_mfma_f32_16x16x32_bf16 v[112:115], a[68:71], v[52:55], v[112:115]
v_mfma_f32_16x16x32_bf16 v[112:115], a[80:83], v[56:59], v[112:115]
v_mfma_f32_16x16x32_bf16 v[112:115], a[92:95], v[60:63], v[112:115]
v_mfma_f32_16x16x32_bf16 v[112:115], a[104:107], v[64:67], v[112:115]
v_mfma_f32_16x16x32_bf16 v[104:107], a[0:3], v[32:35], v[20:23]
v_mfma_f32_16x16x32_bf16 v[104:107], a[12:15], v[36:39], v[104:107]
v_mfma_f32_16x16x32_bf16 v[104:107], a[24:27], v[40:43], v[104:107]
s_waitcnt vmcnt(17) lgkmcnt(2)
s_barrier
v_mfma_f32_16x16x32_bf16 v[104:107], a[36:39], v[44:47], v[104:107]
ds_read_b128 v[68:71], v1 offset:53248
v_mfma_f32_16x16x32_bf16 v[104:107], a[48:51], v[48:51], v[104:107]
ds_read_b128 v[72:75], v1 offset:53312
v_mfma_f32_16x16x32_bf16 v[104:107], a[60:63], v[52:55], v[104:107]
ds_read_b128 v[76:79], v1 offset:53376
v_mfma_f32_16x16x32_bf16 v[104:107], a[72:75], v[56:59], v[104:107]
v_mfma_f32_16x16x32_bf16 v[104:107], a[84:87], v[60:63], v[104:107]
v_mfma_f32_16x16x32_bf16 v[104:107], a[96:99], v[64:67], v[104:107]
v_mfma_f32_16x16x32_bf16 v[108:111], a[4:7], v[32:35], v[24:27]
ds_read_b128 v[32:35], v2 offset:53248
v_mfma_f32_16x16x32_bf16 v[108:111], a[16:19], v[36:39], v[108:111]
ds_read_b128 v[36:39], v2 offset:53312
v_mfma_f32_16x16x32_bf16 v[108:111], a[28:31], v[40:43], v[108:111]
ds_read_b128 v[40:43], v2 offset:53376
v_mfma_f32_16x16x32_bf16 v[108:111], a[40:43], v[44:47], v[108:111]
ds_read_b128 v[44:47], v3 offset:53248
v_mfma_f32_16x16x32_bf16 v[108:111], a[52:55], v[48:51], v[108:111]
ds_read_b128 v[48:51], v3 offset:53312
v_mfma_f32_16x16x32_bf16 v[108:111], a[64:67], v[52:55], v[108:111]
ds_read_b128 v[52:55], v3 offset:53376
v_mfma_f32_16x16x32_bf16 v[108:111], a[76:79], v[56:59], v[108:111]
ds_read_b128 v[56:59], v1 offset:56320
v_mfma_f32_16x16x32_bf16 v[108:111], a[88:91], v[60:63], v[108:111]
ds_read_b128 v[60:63], v1 offset:56384
v_mfma_f32_16x16x32_bf16 v[108:111], a[100:103], v[64:67], v[108:111]
ds_read_b128 v[64:67], v1 offset:56448
s_waitcnt lgkmcnt(6)
v_mfma_f32_16x16x32_bf16 v[160:163], a[224:227], v[68:71], v[160:163]
buffer_store_dwordx4 v[116:119], v15, s[20:23], s57 offen offset:2048 sc1
v_mfma_f32_16x16x32_bf16 v[160:163], a[236:239], v[72:75], v[160:163]
ds_read_b128 v[128:131], v12 offset:4096
v_add_u32 v12, 4294856448, v12
v_mfma_f32_16x16x32_bf16 v[160:163], a[248:251], v[76:79], v[160:163]
v_mfma_f32_16x16x32_bf16 v[160:163], v[192:195], v[32:35], v[160:163]
v_mfma_f32_16x16x32_bf16 v[160:163], v[204:207], v[36:39], v[160:163]
v_mfma_f32_16x16x32_bf16 v[160:163], v[216:219], v[40:43], v[160:163]
s_waitcnt lgkmcnt(1)
v_mfma_f32_16x16x32_bf16 v[160:163], v[228:231], v[44:47], v[160:163]
v_mfma_f32_16x16x32_bf16 v[160:163], v[240:243], v[48:51], v[160:163]
v_mfma_f32_16x16x32_bf16 v[160:163], v[252:255], v[52:55], v[160:163]
v_mfma_f32_16x16x32_bf16 v[152:155], a[216:219], v[68:71], v[152:155]
v_mfma_f32_16x16x32_bf16 v[152:155], a[228:231], v[72:75], v[152:155]
v_mfma_f32_16x16x32_bf16 v[152:155], a[240:243], v[76:79], v[152:155]
v_mfma_f32_16x16x32_bf16 v[152:155], a[252:255], v[32:35], v[152:155]
v_mfma_f32_16x16x32_bf16 v[152:155], v[196:199], v[36:39], v[152:155]
v_mfma_f32_16x16x32_bf16 v[152:155], v[208:211], v[40:43], v[152:155]
v_mfma_f32_16x16x32_bf16 v[152:155], v[220:223], v[44:47], v[152:155]
v_mfma_f32_16x16x32_bf16 v[152:155], v[232:235], v[48:51], v[152:155]
buffer_store_dwordx4 v[120:123], v13, s[20:23], s57 offen offset:3072 sc1
v_mfma_f32_16x16x32_bf16 v[152:155], v[244:247], v[52:55], v[152:155]
ds_read_b128 v[132:135], v12 offset:0
v_cvt_pk_bf16_f32 v160, v160, v161
v_mfma_f32_16x16x32_bf16 v[156:159], a[220:223], v[68:71], v[156:159]
v_cvt_pk_bf16_f32 v161, v162, v163
v_mfma_f32_16x16x32_bf16 v[156:159], a[232:235], v[72:75], v[156:159]
ds_write_b32 v11, v160 offset:0
v_mfma_f32_16x16x32_bf16 v[156:159], a[244:247], v[76:79], v[156:159]
ds_write_b32 v11, v161 offset:4
v_mfma_f32_16x16x32_bf16 v[156:159], v[188:191], v[32:35], v[156:159]
v_mfma_f32_16x16x32_bf16 v[156:159], v[200:203], v[36:39], v[156:159]
v_mfma_f32_16x16x32_bf16 v[156:159], v[212:215], v[40:43], v[156:159]
v_mfma_f32_16x16x32_bf16 v[156:159], v[224:227], v[44:47], v[156:159]
v_mfma_f32_16x16x32_bf16 v[156:159], v[236:239], v[48:51], v[156:159]
v_cvt_pk_bf16_f32 v152, v152, v153
v_cvt_pk_bf16_f32 v153, v154, v155
v_mfma_f32_16x16x32_bf16 v[156:159], v[248:251], v[52:55], v[156:159]
ds_write_b32 v9, v152 offset:0
v_mfma_f32_16x16x32_bf16 v[88:91], a[116:119], v[68:71], v[88:91]
ds_write_b32 v9, v153 offset:4
v_mfma_f32_16x16x32_bf16 v[88:91], a[128:131], v[72:75], v[88:91]
v_mfma_f32_16x16x32_bf16 v[88:91], a[140:143], v[76:79], v[88:91]
v_mfma_f32_16x16x32_bf16 v[88:91], a[152:155], v[32:35], v[88:91]
v_mfma_f32_16x16x32_bf16 v[88:91], a[164:167], v[36:39], v[88:91]
v_mfma_f32_16x16x32_bf16 v[88:91], a[176:179], v[40:43], v[88:91]
s_waitcnt lgkmcnt(5)
v_mfma_f32_16x16x32_bf16 v[88:91], a[188:191], v[44:47], v[88:91]
buffer_store_dwordx4 v[128:131], v16, s[20:23], s57 offen offset:0 sc1
v_mfma_f32_16x16x32_bf16 v[88:91], a[200:203], v[48:51], v[88:91]
ds_read_b128 v[152:155], v12 offset:1024
s_add_u32 s57, s57, s41
v_mfma_f32_16x16x32_bf16 v[88:91], a[212:215], v[52:55], v[88:91]
v_cvt_pk_bf16_f32 v156, v156, v157
v_cvt_pk_bf16_f32 v157, v158, v159
v_mfma_f32_16x16x32_bf16 v[80:83], a[108:111], v[68:71], v[80:83]
ds_write_b32 v10, v156 offset:0
v_mfma_f32_16x16x32_bf16 v[80:83], a[120:123], v[72:75], v[80:83]
ds_write_b32 v10, v157 offset:4
Lstub10:
s_cbranch_execz Lstub14
v_mfma_f32_16x16x32_bf16 v[80:83], a[132:135], v[76:79], v[80:83]
v_mfma_f32_16x16x32_bf16 v[80:83], a[144:147], v[32:35], v[80:83]
v_mfma_f32_16x16x32_bf16 v[80:83], a[156:159], v[36:39], v[80:83]
v_mfma_f32_16x16x32_bf16 v[80:83], a[168:171], v[40:43], v[80:83]
v_mfma_f32_16x16x32_bf16 v[80:83], a[180:183], v[44:47], v[80:83]
v_mfma_f32_16x16x32_bf16 v[80:83], a[192:195], v[48:51], v[80:83]
v_mfma_f32_16x16x32_bf16 v[80:83], a[204:207], v[52:55], v[80:83]
v_mfma_f32_16x16x32_bf16 v[84:87], a[112:115], v[68:71], v[84:87]
v_mfma_f32_16x16x32_bf16 v[84:87], a[124:127], v[72:75], v[84:87]
v_mfma_f32_16x16x32_bf16 v[84:87], a[136:139], v[76:79], v[84:87]
v_mfma_f32_16x16x32_bf16 v[84:87], a[148:151], v[32:35], v[84:87]
v_mfma_f32_16x16x32_bf16 v[84:87], a[160:163], v[36:39], v[84:87]
s_waitcnt lgkmcnt(7)
v_mfma_f32_16x16x32_bf16 v[84:87], a[172:175], v[40:43], v[84:87]
buffer_store_dwordx4 v[132:135], v13, s[20:23], s57 offen offset:0 sc1
v_mfma_f32_16x16x32_bf16 v[84:87], a[184:187], v[44:47], v[84:87]
ds_read_b128 v[156:159], v12 offset:2048
v_mfma_f32_16x16x32_bf16 v[84:87], a[196:199], v[48:51], v[84:87]
v_mfma_f32_16x16x32_bf16 v[84:87], a[208:211], v[52:55], v[84:87]
v_mfma_f32_16x16x32_bf16 v[124:127], a[8:11], v[68:71], v[28:31]
v_mfma_f32_16x16x32_bf16 v[124:127], a[20:23], v[72:75], v[124:127]
v_mfma_f32_16x16x32_bf16 v[124:127], a[32:35], v[76:79], v[124:127]
v_mfma_f32_16x16x32_bf16 v[124:127], a[44:47], v[32:35], v[124:127]
v_mfma_f32_16x16x32_bf16 v[124:127], a[56:59], v[36:39], v[124:127]
v_mfma_f32_16x16x32_bf16 v[124:127], a[68:71], v[40:43], v[124:127]
v_mfma_f32_16x16x32_bf16 v[124:127], a[80:83], v[44:47], v[124:127]
v_mfma_f32_16x16x32_bf16 v[124:127], a[92:95], v[48:51], v[124:127]
v_mfma_f32_16x16x32_bf16 v[124:127], a[104:107], v[52:55], v[124:127]
v_mfma_f32_16x16x32_bf16 v[116:119], a[0:3], v[68:71], v[20:23]
v_mfma_f32_16x16x32_bf16 v[116:119], a[12:15], v[72:75], v[116:119]
v_mfma_f32_16x16x32_bf16 v[116:119], a[24:27], v[76:79], v[116:119]
v_mfma_f32_16x16x32_bf16 v[116:119], a[36:39], v[32:35], v[116:119]
s_waitcnt lgkmcnt(3)
v_mfma_f32_16x16x32_bf16 v[116:119], a[48:51], v[36:39], v[116:119]
buffer_store_dwordx4 v[152:155], v14, s[20:23], s57 offen offset:1024 sc1
v_mfma_f32_16x16x32_bf16 v[116:119], a[60:63], v[40:43], v[116:119]
ds_read_b128 v[152:155], v12 offset:3072
v_mfma_f32_16x16x32_bf16 v[116:119], a[72:75], v[44:47], v[116:119]
v_mfma_f32_16x16x32_bf16 v[116:119], a[84:87], v[48:51], v[116:119]
v_mfma_f32_16x16x32_bf16 v[116:119], a[96:99], v[52:55], v[116:119]
v_mfma_f32_16x16x32_bf16 v[120:123], a[4:7], v[68:71], v[24:27]
ds_read_b128 v[68:71], v2 offset:56320
v_mfma_f32_16x16x32_bf16 v[120:123], a[16:19], v[72:75], v[120:123]
ds_read_b128 v[72:75], v2 offset:56384
v_mfma_f32_16x16x32_bf16 v[120:123], a[28:31], v[76:79], v[120:123]
ds_read_b128 v[76:79], v2 offset:56448
v_mfma_f32_16x16x32_bf16 v[120:123], a[40:43], v[32:35], v[120:123]
ds_read_b128 v[32:35], v3 offset:56320
v_mfma_f32_16x16x32_bf16 v[120:123], a[52:55], v[36:39], v[120:123]
ds_read_b128 v[36:39], v3 offset:56384
v_mfma_f32_16x16x32_bf16 v[120:123], a[64:67], v[40:43], v[120:123]
ds_read_b128 v[40:43], v3 offset:56448
v_mfma_f32_16x16x32_bf16 v[120:123], a[76:79], v[44:47], v[120:123]
ds_read_b128 v[44:47], v1 offset:59392
v_mfma_f32_16x16x32_bf16 v[120:123], a[88:91], v[48:51], v[120:123]
ds_read_b128 v[48:51], v1 offset:59456
v_mfma_f32_16x16x32_bf16 v[120:123], a[100:103], v[52:55], v[120:123]
ds_read_b128 v[52:55], v1 offset:59520
v_mfma_f32_16x16x32_bf16 v[172:175], a[224:227], v[56:59], v[172:175]
v_mfma_f32_16x16x32_bf16 v[172:175], a[236:239], v[60:63], v[172:175]
v_mfma_f32_16x16x32_bf16 v[172:175], a[248:251], v[64:67], v[172:175]
s_waitcnt lgkmcnt(10)
s_waitcnt lgkmcnt(3)
v_mfma_f32_16x16x32_bf16 v[172:175], v[192:195], v[68:71], v[172:175]
buffer_store_dwordx4 v[156:159], v15, s[20:23], s57 offen offset:2048 sc1
v_mfma_f32_16x16x32_bf16 v[172:175], v[204:207], v[72:75], v[172:175]
ds_read_b128 v[156:159], v12 offset:4096
v_add_u32 v12, 4294948096, v12
v_mfma_f32_16x16x32_bf16 v[172:175], v[216:219], v[76:79], v[172:175]
v_mfma_f32_16x16x32_bf16 v[172:175], v[228:231], v[32:35], v[172:175]
v_mfma_f32_16x16x32_bf16 v[172:175], v[240:243], v[36:39], v[172:175]
v_mfma_f32_16x16x32_bf16 v[172:175], v[252:255], v[40:43], v[172:175]
v_mfma_f32_16x16x32_bf16 v[164:167], a[216:219], v[56:59], v[164:167]
v_mfma_f32_16x16x32_bf16 v[164:167], a[228:231], v[60:63], v[164:167]
v_mfma_f32_16x16x32_bf16 v[164:167], a[240:243], v[64:67], v[164:167]
v_mfma_f32_16x16x32_bf16 v[164:167], a[252:255], v[68:71], v[164:167]
v_mfma_f32_16x16x32_bf16 v[164:167], v[196:199], v[72:75], v[164:167]
v_mfma_f32_16x16x32_bf16 v[164:167], v[208:211], v[76:79], v[164:167]
v_mfma_f32_16x16x32_bf16 v[164:167], v[220:223], v[32:35], v[164:167]
v_mfma_f32_16x16x32_bf16 v[164:167], v[232:235], v[36:39], v[164:167]
v_cvt_pk_bf16_f32 v172, v172, v173
v_cvt_pk_bf16_f32 v173, v174, v175
v_mfma_f32_16x16x32_bf16 v[164:167], v[244:247], v[40:43], v[164:167]
ds_write_b32 v11, v172 offset:3072
v_mfma_f32_16x16x32_bf16 v[168:171], a[220:223], v[56:59], v[168:171]
ds_write_b32 v11, v173 offset:3076
v_mfma_f32_16x16x32_bf16 v[168:171], a[232:235], v[60:63], v[168:171]
buffer_store_dwordx4 v[152:155], v13, s[20:23], s57 offen offset:3072 sc1
v_mfma_f32_16x16x32_bf16 v[168:171], a[244:247], v[64:67], v[168:171]
v_mfma_f32_16x16x32_bf16 v[168:171], v[188:191], v[68:71], v[168:171]
v_mfma_f32_16x16x32_bf16 v[168:171], v[200:203], v[72:75], v[168:171]
v_mfma_f32_16x16x32_bf16 v[168:171], v[212:215], v[76:79], v[168:171]
v_mfma_f32_16x16x32_bf16 v[168:171], v[224:227], v[32:35], v[168:171]
v_mfma_f32_16x16x32_bf16 v[168:171], v[236:239], v[36:39], v[168:171]
v_cvt_pk_bf16_f32 v164, v164, v165
v_cvt_pk_bf16_f32 v165, v166, v167
v_mfma_f32_16x16x32_bf16 v[168:171], v[248:251], v[40:43], v[168:171]
ds_write_b32 v9, v164 offset:3072
v_mfma_f32_16x16x32_bf16 v[100:103], a[116:119], v[56:59], v[100:103]
ds_write_b32 v9, v165 offset:3076
v_mfma_f32_16x16x32_bf16 v[100:103], a[128:131], v[60:63], v[100:103]
v_mfma_f32_16x16x32_bf16 v[100:103], a[140:143], v[64:67], v[100:103]
v_mfma_f32_16x16x32_bf16 v[100:103], a[152:155], v[68:71], v[100:103]
v_mfma_f32_16x16x32_bf16 v[100:103], a[164:167], v[72:75], v[100:103]
v_mfma_f32_16x16x32_bf16 v[100:103], a[176:179], v[76:79], v[100:103]
v_mfma_f32_16x16x32_bf16 v[100:103], a[188:191], v[32:35], v[100:103]
v_mfma_f32_16x16x32_bf16 v[100:103], a[200:203], v[36:39], v[100:103]
v_cvt_pk_bf16_f32 v168, v168, v169
v_cvt_pk_bf16_f32 v169, v170, v171
v_mfma_f32_16x16x32_bf16 v[100:103], a[212:215], v[40:43], v[100:103]
ds_write_b32 v10, v168 offset:3072
v_mfma_f32_16x16x32_bf16 v[92:95], a[108:111], v[56:59], v[92:95]
ds_write_b32 v10, v169 offset:3076
v_mfma_f32_16x16x32_bf16 v[92:95], a[120:123], v[60:63], v[92:95]
s_waitcnt lgkmcnt(6)
v_mfma_f32_16x16x32_bf16 v[92:95], a[132:135], v[64:67], v[92:95]
buffer_store_dwordx4 v[156:159], v16, s[20:23], s57 offen offset:0 sc1
v_mfma_f32_16x16x32_bf16 v[92:95], a[144:147], v[68:71], v[92:95]
s_add_u32 s57, s57, s41
v_mfma_f32_16x16x32_bf16 v[92:95], a[156:159], v[72:75], v[92:95]
v_mfma_f32_16x16x32_bf16 v[92:95], a[168:171], v[76:79], v[92:95]
v_mfma_f32_16x16x32_bf16 v[92:95], a[180:183], v[32:35], v[92:95]
v_mfma_f32_16x16x32_bf16 v[92:95], a[192:195], v[36:39], v[92:95]
v_mfma_f32_16x16x32_bf16 v[92:95], a[204:207], v[40:43], v[92:95]
v_mfma_f32_16x16x32_bf16 v[96:99], a[112:115], v[56:59], v[96:99]
v_mfma_f32_16x16x32_bf16 v[96:99], a[124:127], v[60:63], v[96:99]
v_mfma_f32_16x16x32_bf16 v[96:99], a[136:139], v[64:67], v[96:99]
v_mfma_f32_16x16x32_bf16 v[96:99], a[148:151], v[68:71], v[96:99]
v_mfma_f32_16x16x32_bf16 v[96:99], a[160:163], v[72:75], v[96:99]
v_mfma_f32_16x16x32_bf16 v[96:99], a[172:175], v[76:79], v[96:99]
v_mfma_f32_16x16x32_bf16 v[96:99], a[184:187], v[32:35], v[96:99]
Lstub11:
s_cbranch_execz Lstub15
v_mfma_f32_16x16x32_bf16 v[96:99], a[196:199], v[36:39], v[96:99]
v_mfma_f32_16x16x32_bf16 v[96:99], a[208:211], v[40:43], v[96:99]
v_mfma_f32_16x16x32_bf16 v[136:139], a[8:11], v[56:59], v[28:31]
v_mfma_f32_16x16x32_bf16 v[136:139], a[20:23], v[60:63], v[136:139]
v_mfma_f32_16x16x32_bf16 v[136:139], a[32:35], v[64:67], v[136:139]
v_mfma_f32_16x16x32_bf16 v[136:139], a[44:47], v[68:71], v[136:139]
v_mfma_f32_16x16x32_bf16 v[136:139], a[56:59], v[72:75], v[136:139]
v_mfma_f32_16x16x32_bf16 v[136:139], a[68:71], v[76:79], v[136:139]
v_mfma_f32_16x16x32_bf16 v[136:139], a[80:83], v[32:35], v[136:139]
v_mfma_f32_16x16x32_bf16 v[136:139], a[92:95], v[36:39], v[136:139]
v_mfma_f32_16x16x32_bf16 v[136:139], a[104:107], v[40:43], v[136:139]
v_mfma_f32_16x16x32_bf16 v[128:131], a[0:3], v[56:59], v[20:23]
v_mfma_f32_16x16x32_bf16 v[128:131], a[12:15], v[60:63], v[128:131]
v_mfma_f32_16x16x32_bf16 v[128:131], a[24:27], v[64:67], v[128:131]
v_mfma_f32_16x16x32_bf16 v[128:131], a[36:39], v[68:71], v[128:131]
v_mfma_f32_16x16x32_bf16 v[128:131], a[48:51], v[72:75], v[128:131]
v_mfma_f32_16x16x32_bf16 v[128:131], a[60:63], v[76:79], v[128:131]
v_mfma_f32_16x16x32_bf16 v[128:131], a[72:75], v[32:35], v[128:131]
v_mfma_f32_16x16x32_bf16 v[128:131], a[84:87], v[36:39], v[128:131]
v_mfma_f32_16x16x32_bf16 v[128:131], a[96:99], v[40:43], v[128:131]
v_mfma_f32_16x16x32_bf16 v[132:135], a[4:7], v[56:59], v[24:27]
ds_read_b128 v[56:59], v2 offset:59392
v_mfma_f32_16x16x32_bf16 v[132:135], a[16:19], v[60:63], v[132:135]
ds_read_b128 v[60:63], v2 offset:59456
v_mfma_f32_16x16x32_bf16 v[132:135], a[28:31], v[64:67], v[132:135]
ds_read_b128 v[64:67], v2 offset:59520
v_mfma_f32_16x16x32_bf16 v[132:135], a[40:43], v[68:71], v[132:135]
ds_read_b128 v[68:71], v3 offset:59392
v_mfma_f32_16x16x32_bf16 v[132:135], a[52:55], v[72:75], v[132:135]
ds_read_b128 v[72:75], v3 offset:59456
v_mfma_f32_16x16x32_bf16 v[132:135], a[64:67], v[76:79], v[132:135]
ds_read_b128 v[76:79], v3 offset:59520
v_add_u32 v1, 72448, v1
v_mfma_f32_16x16x32_bf16 v[132:135], a[76:79], v[32:35], v[132:135]
v_add_u32 v2, 72448, v2
v_add_u32 v3, 72448, v3
v_mfma_f32_16x16x32_bf16 v[132:135], a[88:91], v[36:39], v[132:135]
v_mfma_f32_16x16x32_bf16 v[132:135], a[100:103], v[40:43], v[132:135]
v_mfma_f32_16x16x32_bf16 v[184:187], a[224:227], v[44:47], v[184:187]
v_mfma_f32_16x16x32_bf16 v[184:187], a[236:239], v[48:51], v[184:187]
v_mfma_f32_16x16x32_bf16 v[184:187], a[248:251], v[52:55], v[184:187]
s_waitcnt lgkmcnt(0)
v_mfma_f32_16x16x32_bf16 v[184:187], v[192:195], v[56:59], v[184:187]
v_mfma_f32_16x16x32_bf16 v[184:187], v[204:207], v[60:63], v[184:187]
v_mfma_f32_16x16x32_bf16 v[184:187], v[216:219], v[64:67], v[184:187]
v_mfma_f32_16x16x32_bf16 v[184:187], v[228:231], v[68:71], v[184:187]
v_mfma_f32_16x16x32_bf16 v[184:187], v[240:243], v[72:75], v[184:187]
v_mfma_f32_16x16x32_bf16 v[184:187], v[252:255], v[76:79], v[184:187]
v_mfma_f32_16x16x32_bf16 v[176:179], a[216:219], v[44:47], v[176:179]
v_mfma_f32_16x16x32_bf16 v[176:179], a[228:231], v[48:51], v[176:179]
v_mfma_f32_16x16x32_bf16 v[176:179], a[240:243], v[52:55], v[176:179]
v_mfma_f32_16x16x32_bf16 v[176:179], a[252:255], v[56:59], v[176:179]
v_mfma_f32_16x16x32_bf16 v[176:179], v[196:199], v[60:63], v[176:179]
v_mfma_f32_16x16x32_bf16 v[176:179], v[208:211], v[64:67], v[176:179]
v_mfma_f32_16x16x32_bf16 v[176:179], v[220:223], v[68:71], v[176:179]
v_mfma_f32_16x16x32_bf16 v[176:179], v[232:235], v[72:75], v[176:179]
v_cvt_pk_bf16_f32 v184, v184, v185
v_cvt_pk_bf16_f32 v185, v186, v187
v_mfma_f32_16x16x32_bf16 v[176:179], v[244:247], v[76:79], v[176:179]
ds_write_b32 v11, v184 offset:6144
v_mfma_f32_16x16x32_bf16 v[180:183], a[220:223], v[44:47], v[180:183]
ds_write_b32 v11, v185 offset:6148
v_mfma_f32_16x16x32_bf16 v[180:183], a[232:235], v[48:51], v[180:183]
v_mfma_f32_16x16x32_bf16 v[180:183], a[244:247], v[52:55], v[180:183]
v_mfma_f32_16x16x32_bf16 v[180:183], v[188:191], v[56:59], v[180:183]
v_mfma_f32_16x16x32_bf16 v[180:183], v[200:203], v[60:63], v[180:183]
v_mfma_f32_16x16x32_bf16 v[180:183], v[212:215], v[64:67], v[180:183]
v_mfma_f32_16x16x32_bf16 v[180:183], v[224:227], v[68:71], v[180:183]
v_mfma_f32_16x16x32_bf16 v[180:183], v[236:239], v[72:75], v[180:183]
v_cvt_pk_bf16_f32 v176, v176, v177
v_cvt_pk_bf16_f32 v177, v178, v179
v_mfma_f32_16x16x32_bf16 v[180:183], v[248:251], v[76:79], v[180:183]
ds_write_b32 v9, v176 offset:6144
v_mfma_f32_16x16x32_bf16 v[112:115], a[116:119], v[44:47], v[112:115]
ds_write_b32 v9, v177 offset:6148
v_mfma_f32_16x16x32_bf16 v[112:115], a[128:131], v[48:51], v[112:115]
v_mfma_f32_16x16x32_bf16 v[112:115], a[140:143], v[52:55], v[112:115]
v_mfma_f32_16x16x32_bf16 v[112:115], a[152:155], v[56:59], v[112:115]
v_mfma_f32_16x16x32_bf16 v[112:115], a[164:167], v[60:63], v[112:115]
v_mfma_f32_16x16x32_bf16 v[112:115], a[176:179], v[64:67], v[112:115]
v_mfma_f32_16x16x32_bf16 v[112:115], a[188:191], v[68:71], v[112:115]
v_mfma_f32_16x16x32_bf16 v[112:115], a[200:203], v[72:75], v[112:115]
v_cvt_pk_bf16_f32 v180, v180, v181
v_cvt_pk_bf16_f32 v181, v182, v183
v_mfma_f32_16x16x32_bf16 v[112:115], a[212:215], v[76:79], v[112:115]
ds_write_b32 v10, v180 offset:6144
v_mfma_f32_16x16x32_bf16 v[104:107], a[108:111], v[44:47], v[104:107]
ds_write_b32 v10, v181 offset:6148
v_mfma_f32_16x16x32_bf16 v[104:107], a[120:123], v[48:51], v[104:107]
v_mfma_f32_16x16x32_bf16 v[104:107], a[132:135], v[52:55], v[104:107]
v_mfma_f32_16x16x32_bf16 v[104:107], a[144:147], v[56:59], v[104:107]
v_mfma_f32_16x16x32_bf16 v[104:107], a[156:159], v[60:63], v[104:107]
v_mfma_f32_16x16x32_bf16 v[104:107], a[168:171], v[64:67], v[104:107]
v_mfma_f32_16x16x32_bf16 v[104:107], a[180:183], v[68:71], v[104:107]
v_mfma_f32_16x16x32_bf16 v[104:107], a[192:195], v[72:75], v[104:107]
v_mfma_f32_16x16x32_bf16 v[104:107], a[204:207], v[76:79], v[104:107]
v_mfma_f32_16x16x32_bf16 v[108:111], a[112:115], v[44:47], v[108:111]
v_mfma_f32_16x16x32_bf16 v[108:111], a[124:127], v[48:51], v[108:111]
v_mfma_f32_16x16x32_bf16 v[108:111], a[136:139], v[52:55], v[108:111]
v_mfma_f32_16x16x32_bf16 v[108:111], a[148:151], v[56:59], v[108:111]
v_mfma_f32_16x16x32_bf16 v[108:111], a[160:163], v[60:63], v[108:111]
v_mfma_f32_16x16x32_bf16 v[108:111], a[172:175], v[64:67], v[108:111]
v_mfma_f32_16x16x32_bf16 v[108:111], a[184:187], v[68:71], v[108:111]
v_mfma_f32_16x16x32_bf16 v[108:111], a[196:199], v[72:75], v[108:111]
v_mfma_f32_16x16x32_bf16 v[108:111], a[208:211], v[76:79], v[108:111]
v_mfma_f32_16x16x32_bf16 v[148:151], a[8:11], v[44:47], v[28:31]
v_mfma_f32_16x16x32_bf16 v[148:151], a[20:23], v[48:51], v[148:151]
v_mfma_f32_16x16x32_bf16 v[148:151], a[32:35], v[52:55], v[148:151]
v_mfma_f32_16x16x32_bf16 v[148:151], a[44:47], v[56:59], v[148:151]
v_mfma_f32_16x16x32_bf16 v[148:151], a[56:59], v[60:63], v[148:151]
v_mfma_f32_16x16x32_bf16 v[148:151], a[68:71], v[64:67], v[148:151]
v_mfma_f32_16x16x32_bf16 v[148:151], a[80:83], v[68:71], v[148:151]
v_mfma_f32_16x16x32_bf16 v[148:151], a[92:95], v[72:75], v[148:151]
v_mfma_f32_16x16x32_bf16 v[148:151], a[104:107], v[76:79], v[148:151]
v_mfma_f32_16x16x32_bf16 v[140:143], a[0:3], v[44:47], v[20:23]
v_mfma_f32_16x16x32_bf16 v[140:143], a[12:15], v[48:51], v[140:143]
v_mfma_f32_16x16x32_bf16 v[140:143], a[24:27], v[52:55], v[140:143]
s_waitcnt vmcnt(20) lgkmcnt(0)
s_barrier
v_mfma_f32_16x16x32_bf16 v[140:143], a[36:39], v[56:59], v[140:143]
ds_read_b128 v[32:35], v1 offset:0
v_mfma_f32_16x16x32_bf16 v[140:143], a[48:51], v[60:63], v[140:143]
ds_read_b128 v[36:39], v1 offset:64
v_mfma_f32_16x16x32_bf16 v[140:143], a[60:63], v[64:67], v[140:143]
ds_read_b128 v[40:43], v1 offset:128
v_mfma_f32_16x16x32_bf16 v[140:143], a[72:75], v[68:71], v[140:143]
ds_read_b128 v[152:155], v12 offset:0
v_mfma_f32_16x16x32_bf16 v[140:143], a[84:87], v[72:75], v[140:143]
ds_read_b128 v[156:159], v12 offset:1024
Lstub12:
s_cbranch_execz Lstub16
v_mfma_f32_16x16x32_bf16 v[140:143], a[96:99], v[76:79], v[140:143]
v_mfma_f32_16x16x32_bf16 v[144:147], a[4:7], v[44:47], v[24:27]
ds_read_b128 v[44:47], v2 offset:0
v_mfma_f32_16x16x32_bf16 v[144:147], a[16:19], v[48:51], v[144:147]
ds_read_b128 v[48:51], v2 offset:64
v_mfma_f32_16x16x32_bf16 v[144:147], a[28:31], v[52:55], v[144:147]
ds_read_b128 v[52:55], v2 offset:128
v_mfma_f32_16x16x32_bf16 v[144:147], a[40:43], v[56:59], v[144:147]
ds_read_b128 v[56:59], v3 offset:0
v_mfma_f32_16x16x32_bf16 v[144:147], a[52:55], v[60:63], v[144:147]
ds_read_b128 v[60:63], v3 offset:64
v_mfma_f32_16x16x32_bf16 v[144:147], a[64:67], v[64:67], v[144:147]
ds_read_b128 v[64:67], v3 offset:128
v_mfma_f32_16x16x32_bf16 v[144:147], a[76:79], v[68:71], v[144:147]
ds_read_b128 v[68:71], v1 offset:3072
v_mfma_f32_16x16x32_bf16 v[144:147], a[88:91], v[72:75], v[144:147]
ds_read_b128 v[72:75], v1 offset:3136
v_mfma_f32_16x16x32_bf16 v[144:147], a[100:103], v[76:79], v[144:147]
ds_read_b128 v[76:79], v1 offset:3200
s_waitcnt lgkmcnt(6)
v_mfma_f32_16x16x32_bf16 v[88:91], a[224:227], v[32:35], v[88:91]
buffer_store_dwordx4 v[152:155], v13, s[20:23], s57 offen offset:0 sc1
v_mfma_f32_16x16x32_bf16 v[88:91], a[236:239], v[36:39], v[88:91]
ds_read_b128 v[164:167], v12 offset:2048
v_mfma_f32_16x16x32_bf16 v[88:91], a[248:251], v[40:43], v[88:91]
v_mfma_f32_16x16x32_bf16 v[88:91], v[192:195], v[44:47], v[88:91]
v_mfma_f32_16x16x32_bf16 v[88:91], v[204:207], v[48:51], v[88:91]
v_mfma_f32_16x16x32_bf16 v[88:91], v[216:219], v[52:55], v[88:91]
s_waitcnt lgkmcnt(1)
v_mfma_f32_16x16x32_bf16 v[88:91], v[228:231], v[56:59], v[88:91]
v_mfma_f32_16x16x32_bf16 v[88:91], v[240:243], v[60:63], v[88:91]
v_mfma_f32_16x16x32_bf16 v[88:91], v[252:255], v[64:67], v[88:91]
v_mfma_f32_16x16x32_bf16 v[80:83], a[216:219], v[32:35], v[80:83]
v_mfma_f32_16x16x32_bf16 v[80:83], a[228:231], v[36:39], v[80:83]
v_mfma_f32_16x16x32_bf16 v[80:83], a[240:243], v[40:43], v[80:83]
v_mfma_f32_16x16x32_bf16 v[80:83], a[252:255], v[44:47], v[80:83]
v_mfma_f32_16x16x32_bf16 v[80:83], v[196:199], v[48:51], v[80:83]
v_mfma_f32_16x16x32_bf16 v[80:83], v[208:211], v[52:55], v[80:83]
v_mfma_f32_16x16x32_bf16 v[80:83], v[220:223], v[56:59], v[80:83]
v_mfma_f32_16x16x32_bf16 v[80:83], v[232:235], v[60:63], v[80:83]
buffer_store_dwordx4 v[156:159], v14, s[20:23], s57 offen offset:1024 sc1
v_mfma_f32_16x16x32_bf16 v[80:83], v[244:247], v[64:67], v[80:83]
ds_read_b128 v[168:171], v12 offset:3072
v_cvt_pk_bf16_f32 v88, v88, v89
v_mfma_f32_16x16x32_bf16 v[84:87], a[220:223], v[32:35], v[84:87]
v_cvt_pk_bf16_f32 v89, v90, v91
v_mfma_f32_16x16x32_bf16 v[84:87], a[232:235], v[36:39], v[84:87]
ds_write_b32 v11, v88 offset:53248
v_mfma_f32_16x16x32_bf16 v[84:87], a[244:247], v[40:43], v[84:87]
ds_write_b32 v11, v89 offset:53252
v_mfma_f32_16x16x32_bf16 v[84:87], v[188:191], v[44:47], v[84:87]
v_mfma_f32_16x16x32_bf16 v[84:87], v[200:203], v[48:51], v[84:87]
v_mfma_f32_16x16x32_bf16 v[84:87], v[212:215], v[52:55], v[84:87]
v_mfma_f32_16x16x32_bf16 v[84:87], v[224:227], v[56:59], v[84:87]
v_mfma_f32_16x16x32_bf16 v[84:87], v[236:239], v[60:63], v[84:87]
v_cvt_pk_bf16_f32 v80, v80, v81
v_cvt_pk_bf16_f32 v81, v82, v83
v_mfma_f32_16x16x32_bf16 v[84:87], v[248:251], v[64:67], v[84:87]
ds_write_b32 v9, v80 offset:53248
v_mfma_f32_16x16x32_bf16 v[124:127], a[116:119], v[32:35], v[124:127]
ds_write_b32 v9, v81 offset:53252
v_mfma_f32_16x16x32_bf16 v[124:127], a[128:131], v[36:39], v[124:127]
v_and_b32 v6, 15, v0
v_lshrrev_b32 v7, 4, v0
v_mfma_f32_16x16x32_bf16 v[124:127], a[140:143], v[40:43], v[124:127]
v_mul_u32_u24 v5, 0xc0, v6
v_lshlrev_b32 v8, 3, v6
v_mfma_f32_16x16x32_bf16 v[124:127], a[152:155], v[44:47], v[124:127]
v_and_b32 v8, 48, v8
v_lshlrev_b32 v4, 4, v7
v_mfma_f32_16x16x32_bf16 v[124:127], a[164:167], v[48:51], v[124:127]
v_xor_b32 v8, v8, v4
v_add_u32 v8, v8, v5
v_mfma_f32_16x16x32_bf16 v[124:127], a[176:179], v[52:55], v[124:127]
s_waitcnt lgkmcnt(5)
v_add_u32 v5, s45, v5
v_and_b32 v17, 1, v7
v_mfma_f32_16x16x32_bf16 v[124:127], a[188:191], v[56:59], v[124:127]
buffer_store_dwordx4 v[164:167], v15, s[20:23], s57 offen offset:2048 sc1
v_mfma_f32_16x16x32_bf16 v[124:127], a[200:203], v[60:63], v[124:127]
ds_read_b128 v[80:83], v12 offset:4096
v_cvt_pk_bf16_f32 v84, v84, v85
v_mfma_f32_16x16x32_bf16 v[124:127], a[212:215], v[64:67], v[124:127]
v_cvt_pk_bf16_f32 v85, v86, v87
v_lshlrev_b32 v17, 5, v17
v_mfma_f32_16x16x32_bf16 v[116:119], a[108:111], v[32:35], v[116:119]
ds_write_b32 v10, v84 offset:53248
v_mfma_f32_16x16x32_bf16 v[116:119], a[120:123], v[36:39], v[116:119]
ds_write_b32 v10, v85 offset:53252
v_mfma_f32_16x16x32_bf16 v[116:119], a[132:135], v[40:43], v[116:119]
v_lshrrev_b32 v7, 1, v7
v_lshl_add_u32 v17, v7, 4, v17
v_mfma_f32_16x16x32_bf16 v[116:119], a[144:147], v[44:47], v[116:119]
v_add_u32 v17, v17, v5
v_lshl_add_u32 v17, s29, 7, v17
v_mfma_f32_16x16x32_bf16 v[116:119], a[156:159], v[48:51], v[116:119]
v_add3_u32 v5, v5, v4, 64
v_lshrrev_b32 v6, 3, v6
v_mfma_f32_16x16x32_bf16 v[116:119], a[168:171], v[52:55], v[116:119]
v_xor_b32 v6, s29, v6
v_lshl_add_u32 v5, v6, 30, v5
v_mfma_f32_16x16x32_bf16 v[116:119], a[180:183], v[56:59], v[116:119]
v_mov_b32 v7, 9216
v_mul_u32_u24 v7, s30, v7
v_mfma_f32_16x16x32_bf16 v[116:119], a[192:195], v[60:63], v[116:119]
v_add_u32 v8, v8, v7
v_add_u32 v4, 136256, v8
v_mfma_f32_16x16x32_bf16 v[116:119], a[204:207], v[64:67], v[116:119]
v_mfma_f32_16x16x32_bf16 v[120:123], a[112:115], v[32:35], v[120:123]
v_mfma_f32_16x16x32_bf16 v[120:123], a[124:127], v[36:39], v[120:123]
v_mfma_f32_16x16x32_bf16 v[120:123], a[136:139], v[40:43], v[120:123]
v_mfma_f32_16x16x32_bf16 v[120:123], a[148:151], v[44:47], v[120:123]
v_mfma_f32_16x16x32_bf16 v[120:123], a[160:163], v[48:51], v[120:123]
s_waitcnt lgkmcnt(7)
v_mfma_f32_16x16x32_bf16 v[120:123], a[172:175], v[52:55], v[120:123]
buffer_store_dwordx4 v[168:171], v13, s[20:23], s57 offen offset:3072 sc1
v_mfma_f32_16x16x32_bf16 v[120:123], a[184:187], v[56:59], v[120:123]
v_mfma_f32_16x16x32_bf16 v[120:123], a[196:199], v[60:63], v[120:123]
v_mfma_f32_16x16x32_bf16 v[120:123], a[208:211], v[64:67], v[120:123]
v_mfma_f32_16x16x32_bf16 v[160:163], a[8:11], v[32:35], v[28:31]
v_mfma_f32_16x16x32_bf16 v[160:163], a[20:23], v[36:39], v[160:163]
v_mfma_f32_16x16x32_bf16 v[160:163], a[32:35], v[40:43], v[160:163]
v_mfma_f32_16x16x32_bf16 v[160:163], a[44:47], v[44:47], v[160:163]
v_mfma_f32_16x16x32_bf16 v[160:163], a[56:59], v[48:51], v[160:163]
v_mfma_f32_16x16x32_bf16 v[160:163], a[68:71], v[52:55], v[160:163]
v_mfma_f32_16x16x32_bf16 v[160:163], a[80:83], v[56:59], v[160:163]
v_mfma_f32_16x16x32_bf16 v[160:163], a[92:95], v[60:63], v[160:163]
v_mfma_f32_16x16x32_bf16 v[160:163], a[104:107], v[64:67], v[160:163]
v_mfma_f32_16x16x32_bf16 v[152:155], a[0:3], v[32:35], v[20:23]
v_mfma_f32_16x16x32_bf16 v[152:155], a[12:15], v[36:39], v[152:155]
v_mfma_f32_16x16x32_bf16 v[152:155], a[24:27], v[40:43], v[152:155]
v_mfma_f32_16x16x32_bf16 v[152:155], a[36:39], v[44:47], v[152:155]
s_waitcnt lgkmcnt(2)
v_mfma_f32_16x16x32_bf16 v[152:155], a[48:51], v[48:51], v[152:155]
buffer_store_dwordx4 v[80:83], v16, s[20:23], s57 offen offset:0 sc1
v_mfma_f32_16x16x32_bf16 v[152:155], a[60:63], v[52:55], v[152:155]
s_add_u32 s57, s57, s41
v_mfma_f32_16x16x32_bf16 v[152:155], a[72:75], v[56:59], v[152:155]
Lstub13:
s_cbranch_execz Lstub17
v_mfma_f32_16x16x32_bf16 v[152:155], a[84:87], v[60:63], v[152:155]
v_mfma_f32_16x16x32_bf16 v[152:155], a[96:99], v[64:67], v[152:155]
v_mfma_f32_16x16x32_bf16 v[156:159], a[4:7], v[32:35], v[24:27]
ds_read_b128 v[32:35], v2 offset:3072
v_mfma_f32_16x16x32_bf16 v[156:159], a[16:19], v[36:39], v[156:159]
ds_read_b128 v[36:39], v2 offset:3136
v_mfma_f32_16x16x32_bf16 v[156:159], a[28:31], v[40:43], v[156:159]
ds_read_b128 v[40:43], v2 offset:3200
v_mfma_f32_16x16x32_bf16 v[156:159], a[40:43], v[44:47], v[156:159]
ds_read_b128 v[44:47], v3 offset:3072
v_mfma_f32_16x16x32_bf16 v[156:159], a[52:55], v[48:51], v[156:159]
ds_read_b128 v[48:51], v3 offset:3136
v_mfma_f32_16x16x32_bf16 v[156:159], a[64:67], v[52:55], v[156:159]
ds_read_b128 v[52:55], v3 offset:3200
v_mfma_f32_16x16x32_bf16 v[156:159], a[76:79], v[56:59], v[156:159]
ds_read_b128 v[56:59], v1 offset:6144
v_mfma_f32_16x16x32_bf16 v[156:159], a[88:91], v[60:63], v[156:159]
ds_read_b128 v[60:63], v1 offset:6208
v_mfma_f32_16x16x32_bf16 v[156:159], a[100:103], v[64:67], v[156:159]
ds_read_b128 v[64:67], v1 offset:6272
v_mfma_f32_16x16x32_bf16 v[100:103], a[224:227], v[68:71], v[100:103]
v_mfma_f32_16x16x32_bf16 v[100:103], a[236:239], v[72:75], v[100:103]
v_mfma_f32_16x16x32_bf16 v[100:103], a[248:251], v[76:79], v[100:103]
s_waitcnt lgkmcnt(3)
v_mfma_f32_16x16x32_bf16 v[100:103], v[192:195], v[32:35], v[100:103]
v_mfma_f32_16x16x32_bf16 v[100:103], v[204:207], v[36:39], v[100:103]
v_mfma_f32_16x16x32_bf16 v[100:103], v[216:219], v[40:43], v[100:103]
v_mfma_f32_16x16x32_bf16 v[100:103], v[228:231], v[44:47], v[100:103]
v_mfma_f32_16x16x32_bf16 v[100:103], v[240:243], v[48:51], v[100:103]
v_mfma_f32_16x16x32_bf16 v[100:103], v[252:255], v[52:55], v[100:103]
v_mfma_f32_16x16x32_bf16 v[92:95], a[216:219], v[68:71], v[92:95]
v_mfma_f32_16x16x32_bf16 v[92:95], a[228:231], v[72:75], v[92:95]
v_mfma_f32_16x16x32_bf16 v[92:95], a[240:243], v[76:79], v[92:95]
v_mfma_f32_16x16x32_bf16 v[92:95], a[252:255], v[32:35], v[92:95]
v_mfma_f32_16x16x32_bf16 v[92:95], v[196:199], v[36:39], v[92:95]
v_mfma_f32_16x16x32_bf16 v[92:95], v[208:211], v[40:43], v[92:95]
v_mfma_f32_16x16x32_bf16 v[92:95], v[220:223], v[44:47], v[92:95]
v_mfma_f32_16x16x32_bf16 v[92:95], v[232:235], v[48:51], v[92:95]
v_cvt_pk_bf16_f32 v100, v100, v101
v_cvt_pk_bf16_f32 v101, v102, v103
v_mfma_f32_16x16x32_bf16 v[92:95], v[244:247], v[52:55], v[92:95]
ds_write_b32 v11, v100 offset:56320
v_mfma_f32_16x16x32_bf16 v[96:99], a[220:223], v[68:71], v[96:99]
ds_write_b32 v11, v101 offset:56324
v_mfma_f32_16x16x32_bf16 v[96:99], a[232:235], v[72:75], v[96:99]
v_mfma_f32_16x16x32_bf16 v[96:99], a[244:247], v[76:79], v[96:99]
v_mfma_f32_16x16x32_bf16 v[96:99], v[188:191], v[32:35], v[96:99]
v_mfma_f32_16x16x32_bf16 v[96:99], v[200:203], v[36:39], v[96:99]
v_mfma_f32_16x16x32_bf16 v[96:99], v[212:215], v[40:43], v[96:99]
v_mfma_f32_16x16x32_bf16 v[96:99], v[224:227], v[44:47], v[96:99]
v_mfma_f32_16x16x32_bf16 v[96:99], v[236:239], v[48:51], v[96:99]
v_cvt_pk_bf16_f32 v92, v92, v93
v_cvt_pk_bf16_f32 v93, v94, v95
v_mfma_f32_16x16x32_bf16 v[96:99], v[248:251], v[52:55], v[96:99]
ds_write_b32 v9, v92 offset:56320
v_mfma_f32_16x16x32_bf16 v[136:139], a[116:119], v[68:71], v[136:139]
ds_write_b32 v9, v93 offset:56324
v_mfma_f32_16x16x32_bf16 v[136:139], a[128:131], v[72:75], v[136:139]
v_mfma_f32_16x16x32_bf16 v[136:139], a[140:143], v[76:79], v[136:139]
v_mfma_f32_16x16x32_bf16 v[136:139], a[152:155], v[32:35], v[136:139]
v_mfma_f32_16x16x32_bf16 v[136:139], a[164:167], v[36:39], v[136:139]
v_mfma_f32_16x16x32_bf16 v[136:139], a[176:179], v[40:43], v[136:139]
v_mfma_f32_16x16x32_bf16 v[136:139], a[188:191], v[44:47], v[136:139]
v_mfma_f32_16x16x32_bf16 v[136:139], a[200:203], v[48:51], v[136:139]
v_cvt_pk_bf16_f32 v96, v96, v97
v_cvt_pk_bf16_f32 v97, v98, v99
v_mfma_f32_16x16x32_bf16 v[136:139], a[212:215], v[52:55], v[136:139]
ds_write_b32 v10, v96 offset:56320
v_mfma_f32_16x16x32_bf16 v[128:131], a[108:111], v[68:71], v[128:131]
ds_write_b32 v10, v97 offset:56324
v_mfma_f32_16x16x32_bf16 v[128:131], a[120:123], v[72:75], v[128:131]
v_mfma_f32_16x16x32_bf16 v[128:131], a[132:135], v[76:79], v[128:131]
v_mfma_f32_16x16x32_bf16 v[128:131], a[144:147], v[32:35], v[128:131]
v_mfma_f32_16x16x32_bf16 v[128:131], a[156:159], v[36:39], v[128:131]
v_mfma_f32_16x16x32_bf16 v[128:131], a[168:171], v[40:43], v[128:131]
v_mfma_f32_16x16x32_bf16 v[128:131], a[180:183], v[44:47], v[128:131]
v_mfma_f32_16x16x32_bf16 v[128:131], a[192:195], v[48:51], v[128:131]
v_mfma_f32_16x16x32_bf16 v[128:131], a[204:207], v[52:55], v[128:131]
v_mfma_f32_16x16x32_bf16 v[132:135], a[112:115], v[68:71], v[132:135]
v_mfma_f32_16x16x32_bf16 v[132:135], a[124:127], v[72:75], v[132:135]
v_mfma_f32_16x16x32_bf16 v[132:135], a[136:139], v[76:79], v[132:135]
v_mfma_f32_16x16x32_bf16 v[132:135], a[148:151], v[32:35], v[132:135]
v_mfma_f32_16x16x32_bf16 v[132:135], a[160:163], v[36:39], v[132:135]
v_mfma_f32_16x16x32_bf16 v[132:135], a[172:175], v[40:43], v[132:135]
v_mfma_f32_16x16x32_bf16 v[132:135], a[184:187], v[44:47], v[132:135]
v_mfma_f32_16x16x32_bf16 v[132:135], a[196:199], v[48:51], v[132:135]
v_mfma_f32_16x16x32_bf16 v[132:135], a[208:211], v[52:55], v[132:135]
v_mfma_f32_16x16x32_bf16 v[172:175], a[8:11], v[68:71], v[28:31]
v_mfma_f32_16x16x32_bf16 v[172:175], a[20:23], v[72:75], v[172:175]
v_mfma_f32_16x16x32_bf16 v[172:175], a[32:35], v[76:79], v[172:175]
v_mfma_f32_16x16x32_bf16 v[172:175], a[44:47], v[32:35], v[172:175]
v_mfma_f32_16x16x32_bf16 v[172:175], a[56:59], v[36:39], v[172:175]
v_mfma_f32_16x16x32_bf16 v[172:175], a[68:71], v[40:43], v[172:175]
v_mfma_f32_16x16x32_bf16 v[172:175], a[80:83], v[44:47], v[172:175]
v_mfma_f32_16x16x32_bf16 v[172:175], a[92:95], v[48:51], v[172:175]
v_mfma_f32_16x16x32_bf16 v[172:175], a[104:107], v[52:55], v[172:175]
v_mfma_f32_16x16x32_bf16 v[164:167], a[0:3], v[68:71], v[20:23]
v_mfma_f32_16x16x32_bf16 v[164:167], a[12:15], v[72:75], v[164:167]
v_mfma_f32_16x16x32_bf16 v[164:167], a[24:27], v[76:79], v[164:167]
v_mfma_f32_16x16x32_bf16 v[164:167], a[36:39], v[32:35], v[164:167]
v_mfma_f32_16x16x32_bf16 v[164:167], a[48:51], v[36:39], v[164:167]
v_mfma_f32_16x16x32_bf16 v[164:167], a[60:63], v[40:43], v[164:167]
v_mfma_f32_16x16x32_bf16 v[164:167], a[72:75], v[44:47], v[164:167]
v_mfma_f32_16x16x32_bf16 v[164:167], a[84:87], v[48:51], v[164:167]
v_mfma_f32_16x16x32_bf16 v[164:167], a[96:99], v[52:55], v[164:167]
v_mfma_f32_16x16x32_bf16 v[168:171], a[4:7], v[68:71], v[24:27]
ds_read_b128 v[68:71], v2 offset:6144
v_mfma_f32_16x16x32_bf16 v[168:171], a[16:19], v[72:75], v[168:171]
ds_read_b128 v[72:75], v2 offset:6208
v_mfma_f32_16x16x32_bf16 v[168:171], a[28:31], v[76:79], v[168:171]
ds_read_b128 v[76:79], v2 offset:6272
v_mfma_f32_16x16x32_bf16 v[168:171], a[40:43], v[32:35], v[168:171]
ds_read_b128 v[32:35], v3 offset:6144
v_mfma_f32_16x16x32_bf16 v[168:171], a[52:55], v[36:39], v[168:171]
ds_read_b128 v[36:39], v3 offset:6208
v_mfma_f32_16x16x32_bf16 v[168:171], a[64:67], v[40:43], v[168:171]
ds_read_b128 v[40:43], v3 offset:6272
v_mfma_f32_16x16x32_bf16 v[168:171], a[76:79], v[44:47], v[168:171]
v_mfma_f32_16x16x32_bf16 v[168:171], a[88:91], v[48:51], v[168:171]
v_mfma_f32_16x16x32_bf16 v[168:171], a[100:103], v[52:55], v[168:171]
s_waitcnt lgkmcnt(3)
v_mfma_f32_16x16x32_bf16 v[112:115], a[224:227], v[56:59], v[112:115]
v_mfma_f32_16x16x32_bf16 v[112:115], a[236:239], v[60:63], v[112:115]
v_mfma_f32_16x16x32_bf16 v[112:115], a[248:251], v[64:67], v[112:115]
v_mfma_f32_16x16x32_bf16 v[112:115], v[192:195], v[68:71], v[112:115]
v_mfma_f32_16x16x32_bf16 v[112:115], v[204:207], v[72:75], v[112:115]
v_mfma_f32_16x16x32_bf16 v[112:115], v[216:219], v[76:79], v[112:115]
s_waitcnt lgkmcnt(0)
v_mfma_f32_16x16x32_bf16 v[112:115], v[228:231], v[32:35], v[112:115]
Lstub14:
s_cbranch_execz Lwarmdone
v_mfma_f32_16x16x32_bf16 v[112:115], v[240:243], v[36:39], v[112:115]
v_mfma_f32_16x16x32_bf16 v[112:115], v[252:255], v[40:43], v[112:115]
v_mfma_f32_16x16x32_bf16 v[104:107], a[216:219], v[56:59], v[104:107]
v_mfma_f32_16x16x32_bf16 v[104:107], a[228:231], v[60:63], v[104:107]
v_mfma_f32_16x16x32_bf16 v[104:107], a[240:243], v[64:67], v[104:107]
v_mfma_f32_16x16x32_bf16 v[104:107], a[252:255], v[68:71], v[104:107]
v_mfma_f32_16x16x32_bf16 v[104:107], v[196:199], v[72:75], v[104:107]
v_mfma_f32_16x16x32_bf16 v[104:107], v[208:211], v[76:79], v[104:107]
v_mfma_f32_16x16x32_bf16 v[104:107], v[220:223], v[32:35], v[104:107]
v_mfma_f32_16x16x32_bf16 v[104:107], v[232:235], v[36:39], v[104:107]
v_cvt_pk_bf16_f32 v112, v112, v113
v_cvt_pk_bf16_f32 v113, v114, v115
v_mfma_f32_16x16x32_bf16 v[104:107], v[244:247], v[40:43], v[104:107]
ds_write_b32 v11, v112 offset:59392
v_mfma_f32_16x16x32_bf16 v[108:111], a[220:223], v[56:59], v[108:111]
ds_write_b32 v11, v113 offset:59396
v_mfma_f32_16x16x32_bf16 v[108:111], a[232:235], v[60:63], v[108:111]
v_mfma_f32_16x16x32_bf16 v[108:111], a[244:247], v[64:67], v[108:111]
v_mfma_f32_16x16x32_bf16 v[108:111], v[188:191], v[68:71], v[108:111]
v_mfma_f32_16x16x32_bf16 v[108:111], v[200:203], v[72:75], v[108:111]
v_mfma_f32_16x16x32_bf16 v[108:111], v[212:215], v[76:79], v[108:111]
v_mfma_f32_16x16x32_bf16 v[108:111], v[224:227], v[32:35], v[108:111]
v_mfma_f32_16x16x32_bf16 v[108:111], v[236:239], v[36:39], v[108:111]
v_cvt_pk_bf16_f32 v104, v104, v105
v_cvt_pk_bf16_f32 v105, v106, v107
v_mfma_f32_16x16x32_bf16 v[108:111], v[248:251], v[40:43], v[108:111]
ds_write_b32 v9, v104 offset:59392
v_mfma_f32_16x16x32_bf16 v[148:151], a[116:119], v[56:59], v[148:151]
ds_write_b32 v9, v105 offset:59396
v_mfma_f32_16x16x32_bf16 v[148:151], a[128:131], v[60:63], v[148:151]
v_mfma_f32_16x16x32_bf16 v[148:151], a[140:143], v[64:67], v[148:151]
v_mfma_f32_16x16x32_bf16 v[148:151], a[152:155], v[68:71], v[148:151]
v_mfma_f32_16x16x32_bf16 v[148:151], a[164:167], v[72:75], v[148:151]
v_mfma_f32_16x16x32_bf16 v[148:151], a[176:179], v[76:79], v[148:151]
v_mfma_f32_16x16x32_bf16 v[148:151], a[188:191], v[32:35], v[148:151]
v_mfma_f32_16x16x32_bf16 v[148:151], a[200:203], v[36:39], v[148:151]
v_cvt_pk_bf16_f32 v108, v108, v109
v_cvt_pk_bf16_f32 v109, v110, v111
v_mfma_f32_16x16x32_bf16 v[148:151], a[212:215], v[40:43], v[148:151]
ds_write_b32 v10, v108 offset:59392
v_mfma_f32_16x16x32_bf16 v[140:143], a[108:111], v[56:59], v[140:143]
ds_write_b32 v10, v109 offset:59396
v_mfma_f32_16x16x32_bf16 v[140:143], a[120:123], v[60:63], v[140:143]
v_add_u32 v9, 72448, v9
v_add_u32 v10, 72448, v10
v_mfma_f32_16x16x32_bf16 v[140:143], a[132:135], v[64:67], v[140:143]
v_add_u32 v11, 72448, v11
v_mfma_f32_16x16x32_bf16 v[140:143], a[144:147], v[68:71], v[140:143]
v_mfma_f32_16x16x32_bf16 v[140:143], a[156:159], v[72:75], v[140:143]
v_mfma_f32_16x16x32_bf16 v[140:143], a[168:171], v[76:79], v[140:143]
v_mfma_f32_16x16x32_bf16 v[140:143], a[180:183], v[32:35], v[140:143]
v_mfma_f32_16x16x32_bf16 v[140:143], a[192:195], v[36:39], v[140:143]
v_mfma_f32_16x16x32_bf16 v[140:143], a[204:207], v[40:43], v[140:143]
v_mfma_f32_16x16x32_bf16 v[144:147], a[112:115], v[56:59], v[144:147]
v_mfma_f32_16x16x32_bf16 v[144:147], a[124:127], v[60:63], v[144:147]
v_mfma_f32_16x16x32_bf16 v[144:147], a[136:139], v[64:67], v[144:147]
v_mfma_f32_16x16x32_bf16 v[144:147], a[148:151], v[68:71], v[144:147]
v_mfma_f32_16x16x32_bf16 v[144:147], a[160:163], v[72:75], v[144:147]
v_mfma_f32_16x16x32_bf16 v[144:147], a[172:175], v[76:79], v[144:147]
v_mfma_f32_16x16x32_bf16 v[144:147], a[184:187], v[32:35], v[144:147]
v_mfma_f32_16x16x32_bf16 v[144:147], a[196:199], v[36:39], v[144:147]
v_mfma_f32_16x16x32_bf16 v[144:147], a[208:211], v[40:43], v[144:147]
v_mfma_f32_16x16x32_bf16 v[184:187], a[8:11], v[56:59], v[28:31]
v_mfma_f32_16x16x32_bf16 v[184:187], a[20:23], v[60:63], v[184:187]
v_mfma_f32_16x16x32_bf16 v[184:187], a[32:35], v[64:67], v[184:187]
v_mfma_f32_16x16x32_bf16 v[184:187], a[44:47], v[68:71], v[184:187]
v_mfma_f32_16x16x32_bf16 v[184:187], a[56:59], v[72:75], v[184:187]
v_mfma_f32_16x16x32_bf16 v[184:187], a[68:71], v[76:79], v[184:187]
v_mfma_f32_16x16x32_bf16 v[184:187], a[80:83], v[32:35], v[184:187]
v_mfma_f32_16x16x32_bf16 v[184:187], a[92:95], v[36:39], v[184:187]
v_mfma_f32_16x16x32_bf16 v[184:187], a[104:107], v[40:43], v[184:187]
v_mfma_f32_16x16x32_bf16 v[176:179], a[0:3], v[56:59], v[20:23]
v_mfma_f32_16x16x32_bf16 v[176:179], a[12:15], v[60:63], v[176:179]
v_mfma_f32_16x16x32_bf16 v[176:179], a[24:27], v[64:67], v[176:179]
s_waitcnt vmcnt(15) lgkmcnt(0)
s_barrier
v_mfma_f32_16x16x32_bf16 v[176:179], a[36:39], v[68:71], v[176:179]
ds_read_b128 v[44:47], v1 offset:19200
v_mfma_f32_16x16x32_bf16 v[176:179], a[48:51], v[72:75], v[176:179]
ds_read_b128 v[48:51], v1 offset:19264
v_mfma_f32_16x16x32_bf16 v[176:179], a[60:63], v[76:79], v[176:179]
ds_read_b128 v[52:55], v1 offset:19328
v_mfma_f32_16x16x32_bf16 v[176:179], a[72:75], v[32:35], v[176:179]
ds_read_b128 v[80:83], v12 offset:53248
v_mfma_f32_16x16x32_bf16 v[176:179], a[84:87], v[36:39], v[176:179]
ds_read_b128 v[84:87], v12 offset:54272
v_mfma_f32_16x16x32_bf16 v[176:179], a[96:99], v[40:43], v[176:179]
v_mfma_f32_16x16x32_bf16 v[180:183], a[4:7], v[56:59], v[24:27]
ds_read_b128 v[56:59], v2 offset:19200
v_mfma_f32_16x16x32_bf16 v[180:183], a[16:19], v[60:63], v[180:183]
ds_read_b128 v[60:63], v2 offset:19264
v_mfma_f32_16x16x32_bf16 v[180:183], a[28:31], v[64:67], v[180:183]
ds_read_b128 v[64:67], v2 offset:19328
v_mfma_f32_16x16x32_bf16 v[180:183], a[40:43], v[68:71], v[180:183]
ds_read_b128 v[68:71], v3 offset:19200
v_mfma_f32_16x16x32_bf16 v[180:183], a[52:55], v[72:75], v[180:183]
ds_read_b128 v[72:75], v3 offset:19264
v_mfma_f32_16x16x32_bf16 v[180:183], a[64:67], v[76:79], v[180:183]
ds_read_b128 v[76:79], v3 offset:19328
v_mfma_f32_16x16x32_bf16 v[180:183], a[76:79], v[32:35], v[180:183]
ds_read_b128 v[32:35], v1 offset:38400
v_mfma_f32_16x16x32_bf16 v[180:183], a[88:91], v[36:39], v[180:183]
ds_read_b128 v[36:39], v1 offset:38464
v_mfma_f32_16x16x32_bf16 v[180:183], a[100:103], v[40:43], v[180:183]
ds_read_b128 v[40:43], v1 offset:38528
s_waitcnt lgkmcnt(6)
v_mfma_f32_16x16x32_bf16 v[124:127], a[224:227], v[44:47], v[124:127]
buffer_store_dwordx4 v[80:83], v13, s[20:23], s57 offen offset:0 sc1
v_mfma_f32_16x16x32_bf16 v[124:127], a[236:239], v[48:51], v[124:127]
ds_read_b128 v[80:83], v12 offset:55296
v_mfma_f32_16x16x32_bf16 v[124:127], a[248:251], v[52:55], v[124:127]
v_mfma_f32_16x16x32_bf16 v[124:127], v[192:195], v[56:59], v[124:127]
v_mfma_f32_16x16x32_bf16 v[124:127], v[204:207], v[60:63], v[124:127]
v_mfma_f32_16x16x32_bf16 v[124:127], v[216:219], v[64:67], v[124:127]
s_waitcnt lgkmcnt(1)
v_mfma_f32_16x16x32_bf16 v[124:127], v[228:231], v[68:71], v[124:127]
v_mfma_f32_16x16x32_bf16 v[124:127], v[240:243], v[72:75], v[124:127]
v_mfma_f32_16x16x32_bf16 v[124:127], v[252:255], v[76:79], v[124:127]
v_mfma_f32_16x16x32_bf16 v[116:119], a[216:219], v[44:47], v[116:119]
v_mfma_f32_16x16x32_bf16 v[116:119], a[228:231], v[48:51], v[116:119]
v_mfma_f32_16x16x32_bf16 v[116:119], a[240:243], v[52:55], v[116:119]
v_mfma_f32_16x16x32_bf16 v[116:119], a[252:255], v[56:59], v[116:119]
v_mfma_f32_16x16x32_bf16 v[116:119], v[196:199], v[60:63], v[116:119]
v_mfma_f32_16x16x32_bf16 v[116:119], v[208:211], v[64:67], v[116:119]
v_mfma_f32_16x16x32_bf16 v[116:119], v[220:223], v[68:71], v[116:119]
v_mfma_f32_16x16x32_bf16 v[116:119], v[232:235], v[72:75], v[116:119]
buffer_store_dwordx4 v[84:87], v14, s[20:23], s57 offen offset:1024 sc1
v_mfma_f32_16x16x32_bf16 v[116:119], v[244:247], v[76:79], v[116:119]
ds_read_b128 v[84:87], v12 offset:56320
v_cvt_pk_bf16_f32 v124, v124, v125
Lstub15:
s_cbranch_execz Lwarmdone
v_mfma_f32_16x16x32_bf16 v[120:123], a[220:223], v[44:47], v[120:123]
v_cvt_pk_bf16_f32 v125, v126, v127
v_mfma_f32_16x16x32_bf16 v[120:123], a[232:235], v[48:51], v[120:123]
ds_write_b32 v11, v124 offset:0
v_mfma_f32_16x16x32_bf16 v[120:123], a[244:247], v[52:55], v[120:123]
ds_write_b32 v11, v125 offset:4
v_mfma_f32_16x16x32_bf16 v[120:123], v[188:191], v[56:59], v[120:123]
v_mfma_f32_16x16x32_bf16 v[120:123], v[200:203], v[60:63], v[120:123]
v_mfma_f32_16x16x32_bf16 v[120:123], v[212:215], v[64:67], v[120:123]
v_mfma_f32_16x16x32_bf16 v[120:123], v[224:227], v[68:71], v[120:123]
v_mfma_f32_16x16x32_bf16 v[120:123], v[236:239], v[72:75], v[120:123]
v_cvt_pk_bf16_f32 v116, v116, v117
v_cvt_pk_bf16_f32 v117, v118, v119
v_mfma_f32_16x16x32_bf16 v[120:123], v[248:251], v[76:79], v[120:123]
ds_write_b32 v9, v116 offset:0
v_mfma_f32_16x16x32_bf16 v[160:163], a[116:119], v[44:47], v[160:163]
ds_write_b32 v9, v117 offset:4
v_mfma_f32_16x16x32_bf16 v[160:163], a[128:131], v[48:51], v[160:163]
v_mfma_f32_16x16x32_bf16 v[160:163], a[140:143], v[52:55], v[160:163]
v_mfma_f32_16x16x32_bf16 v[160:163], a[152:155], v[56:59], v[160:163]
v_mfma_f32_16x16x32_bf16 v[160:163], a[164:167], v[60:63], v[160:163]
v_mfma_f32_16x16x32_bf16 v[160:163], a[176:179], v[64:67], v[160:163]
s_waitcnt lgkmcnt(5)
v_mfma_f32_16x16x32_bf16 v[160:163], a[188:191], v[68:71], v[160:163]
buffer_store_dwordx4 v[80:83], v15, s[20:23], s57 offen offset:2048 sc1
v_mfma_f32_16x16x32_bf16 v[160:163], a[200:203], v[72:75], v[160:163]
ds_read_b128 v[116:119], v12 offset:57344
v_cvt_pk_bf16_f32 v120, v120, v121
v_mfma_f32_16x16x32_bf16 v[160:163], a[212:215], v[76:79], v[160:163]
v_cvt_pk_bf16_f32 v121, v122, v123
v_add_u32 v12, s31, v12
v_mfma_f32_16x16x32_bf16 v[152:155], a[108:111], v[44:47], v[152:155]
ds_write_b32 v10, v120 offset:0
v_mfma_f32_16x16x32_bf16 v[152:155], a[120:123], v[48:51], v[152:155]
ds_write_b32 v10, v121 offset:4
v_mfma_f32_16x16x32_bf16 v[152:155], a[132:135], v[52:55], v[152:155]
v_add_u32 v12, 72448, v12
v_mfma_f32_16x16x32_bf16 v[152:155], a[144:147], v[56:59], v[152:155]
v_mfma_f32_16x16x32_bf16 v[152:155], a[156:159], v[60:63], v[152:155]
v_mfma_f32_16x16x32_bf16 v[152:155], a[168:171], v[64:67], v[152:155]
v_mfma_f32_16x16x32_bf16 v[152:155], a[180:183], v[68:71], v[152:155]
v_mfma_f32_16x16x32_bf16 v[152:155], a[192:195], v[72:75], v[152:155]
v_mfma_f32_16x16x32_bf16 v[152:155], a[204:207], v[76:79], v[152:155]
v_mfma_f32_16x16x32_bf16 v[156:159], a[112:115], v[44:47], v[156:159]
ds_read_b128 v[44:47], v2 offset:38400
v_mfma_f32_16x16x32_bf16 v[156:159], a[124:127], v[48:51], v[156:159]
ds_read_b128 v[48:51], v2 offset:38464
v_mfma_f32_16x16x32_bf16 v[156:159], a[136:139], v[52:55], v[156:159]
ds_read_b128 v[52:55], v2 offset:38528
v_mfma_f32_16x16x32_bf16 v[156:159], a[148:151], v[56:59], v[156:159]
ds_read_b128 v[56:59], v3 offset:38400
v_mfma_f32_16x16x32_bf16 v[156:159], a[160:163], v[60:63], v[156:159]
ds_read_b128 v[60:63], v3 offset:38464
v_mfma_f32_16x16x32_bf16 v[156:159], a[172:175], v[64:67], v[156:159]
ds_read_b128 v[64:67], v3 offset:38528
v_mfma_f32_16x16x32_bf16 v[156:159], a[184:187], v[68:71], v[156:159]
ds_read_b128 v[68:71], v1 offset:22272
v_mfma_f32_16x16x32_bf16 v[156:159], a[196:199], v[72:75], v[156:159]
ds_read_b128 v[72:75], v1 offset:22336
v_mfma_f32_16x16x32_bf16 v[156:159], a[208:211], v[76:79], v[156:159]
ds_read_b128 v[76:79], v1 offset:22400
v_mfma_f32_16x16x32_bf16 v[160:163], a[224:227], v[32:35], v[160:163]
s_waitcnt lgkmcnt(15)
v_mfma_f32_16x16x32_bf16 v[160:163], a[236:239], v[36:39], v[160:163]
buffer_store_dwordx4 v[84:87], v13, s[20:23], s57 offen offset:3072 sc1
v_mfma_f32_16x16x32_bf16 v[160:163], a[248:251], v[40:43], v[160:163]
s_waitcnt lgkmcnt(3)
v_mfma_f32_16x16x32_bf16 v[160:163], v[192:195], v[44:47], v[160:163]
v_mfma_f32_16x16x32_bf16 v[160:163], v[204:207], v[48:51], v[160:163]
v_mfma_f32_16x16x32_bf16 v[160:163], v[216:219], v[52:55], v[160:163]
v_mfma_f32_16x16x32_bf16 v[160:163], v[228:231], v[56:59], v[160:163]
v_mfma_f32_16x16x32_bf16 v[160:163], v[240:243], v[60:63], v[160:163]
v_mfma_f32_16x16x32_bf16 v[160:163], v[252:255], v[64:67], v[160:163]
v_mfma_f32_16x16x32_bf16 v[152:155], a[216:219], v[32:35], v[152:155]
v_mfma_f32_16x16x32_bf16 v[152:155], a[228:231], v[36:39], v[152:155]
v_mfma_f32_16x16x32_bf16 v[152:155], a[240:243], v[40:43], v[152:155]
v_mfma_f32_16x16x32_bf16 v[152:155], a[252:255], v[44:47], v[152:155]
v_mfma_f32_16x16x32_bf16 v[152:155], v[196:199], v[48:51], v[152:155]
v_mfma_f32_16x16x32_bf16 v[152:155], v[208:211], v[52:55], v[152:155]
v_mfma_f32_16x16x32_bf16 v[152:155], v[220:223], v[56:59], v[152:155]
v_mfma_f32_16x16x32_bf16 v[152:155], v[232:235], v[60:63], v[152:155]
v_cvt_pk_bf16_f32 v160, v160, v161
v_cvt_pk_bf16_f32 v161, v162, v163
v_mfma_f32_16x16x32_bf16 v[152:155], v[244:247], v[64:67], v[152:155]
ds_write_b32 v11, v160 offset:57600
v_mfma_f32_16x16x32_bf16 v[156:159], a[220:223], v[32:35], v[156:159]
ds_read_b128 v[32:35], v2 offset:22272
v_mfma_f32_16x16x32_bf16 v[156:159], a[232:235], v[36:39], v[156:159]
ds_read_b128 v[36:39], v2 offset:22336
v_mfma_f32_16x16x32_bf16 v[156:159], a[244:247], v[40:43], v[156:159]
ds_read_b128 v[40:43], v2 offset:22400
v_mfma_f32_16x16x32_bf16 v[156:159], v[188:191], v[44:47], v[156:159]
ds_read_b128 v[44:47], v3 offset:22272
v_mfma_f32_16x16x32_bf16 v[156:159], v[200:203], v[48:51], v[156:159]
ds_write_b32 v11, v161 offset:57604
v_mfma_f32_16x16x32_bf16 v[156:159], v[212:215], v[52:55], v[156:159]
ds_read_b128 v[48:51], v3 offset:22336
v_mfma_f32_16x16x32_bf16 v[156:159], v[224:227], v[56:59], v[156:159]
ds_read_b128 v[52:55], v3 offset:22400
v_mfma_f32_16x16x32_bf16 v[156:159], v[236:239], v[60:63], v[156:159]
ds_read_b128 v[56:59], v1 offset:41472
v_cvt_pk_bf16_f32 v152, v152, v153
v_mfma_f32_16x16x32_bf16 v[156:159], v[248:251], v[64:67], v[156:159]
ds_read_b128 v[60:63], v1 offset:41536
s_waitcnt lgkmcnt(6)
v_mfma_f32_16x16x32_bf16 v[136:139], a[224:227], v[68:71], v[136:139]
ds_read_b128 v[64:67], v1 offset:41600
v_cvt_pk_bf16_f32 v153, v154, v155
v_mfma_f32_16x16x32_bf16 v[136:139], a[236:239], v[72:75], v[136:139]
ds_write_b32 v9, v152 offset:57600
v_mfma_f32_16x16x32_bf16 v[136:139], a[248:251], v[76:79], v[136:139]
ds_write_b32 v9, v153 offset:57604
v_mfma_f32_16x16x32_bf16 v[136:139], v[192:195], v[32:35], v[136:139]
buffer_store_dwordx4 v[116:119], v16, s[20:23], s57 offen offset:0 sc1
v_mfma_f32_16x16x32_bf16 v[136:139], v[204:207], v[36:39], v[136:139]
s_add_u32 s57, s57, s41
v_subrev_u32 v13, s32, v13
v_subrev_u32 v14, s32, v14
v_mfma_f32_16x16x32_bf16 v[136:139], v[216:219], v[40:43], v[136:139]
s_waitcnt lgkmcnt(3)
v_subrev_u32 v15, s32, v15
s_add_u32 s51, s57, s44
v_mfma_f32_16x16x32_bf16 v[136:139], v[228:231], v[44:47], v[136:139]
v_mfma_f32_16x16x32_bf16 v[136:139], v[240:243], v[48:51], v[136:139]
v_cvt_pk_bf16_f32 v156, v156, v157
v_cvt_pk_bf16_f32 v157, v158, v159
v_mfma_f32_16x16x32_bf16 v[136:139], v[252:255], v[52:55], v[136:139]
ds_write_b32 v10, v156 offset:57600
v_mfma_f32_16x16x32_bf16 v[128:131], a[216:219], v[68:71], v[128:131]
ds_write_b32 v10, v157 offset:57604
v_mfma_f32_16x16x32_bf16 v[128:131], a[228:231], v[72:75], v[128:131]
v_mfma_f32_16x16x32_bf16 v[128:131], a[240:243], v[76:79], v[128:131]
v_mfma_f32_16x16x32_bf16 v[128:131], a[252:255], v[32:35], v[128:131]
Lstub16:
s_cbranch_execz Lwarmdone
v_mfma_f32_16x16x32_bf16 v[128:131], v[196:199], v[36:39], v[128:131]
v_mfma_f32_16x16x32_bf16 v[128:131], v[208:211], v[40:43], v[128:131]
v_mfma_f32_16x16x32_bf16 v[128:131], v[220:223], v[44:47], v[128:131]
v_mfma_f32_16x16x32_bf16 v[128:131], v[232:235], v[48:51], v[128:131]
s_waitcnt lgkmcnt(0)
s_barrier
v_mfma_f32_16x16x32_bf16 v[128:131], v[244:247], v[52:55], v[128:131]
ds_read_b128 v[152:155], v12 offset:0
v_cvt_pk_bf16_f32 v136, v136, v137
v_mfma_f32_16x16x32_bf16 v[132:135], a[220:223], v[68:71], v[132:135]
ds_read_b128 v[156:159], v12 offset:1024
v_cvt_pk_bf16_f32 v137, v138, v139
v_mfma_f32_16x16x32_bf16 v[132:135], a[232:235], v[72:75], v[132:135]
ds_write_b32 v11, v136 offset:3072
v_mfma_f32_16x16x32_bf16 v[132:135], a[244:247], v[76:79], v[132:135]
ds_write_b32 v11, v137 offset:3076
v_mfma_f32_16x16x32_bf16 v[132:135], v[188:191], v[32:35], v[132:135]
v_mfma_f32_16x16x32_bf16 v[132:135], v[200:203], v[36:39], v[132:135]
v_mfma_f32_16x16x32_bf16 v[132:135], v[212:215], v[40:43], v[132:135]
v_mfma_f32_16x16x32_bf16 v[132:135], v[224:227], v[44:47], v[132:135]
v_mfma_f32_16x16x32_bf16 v[132:135], v[236:239], v[48:51], v[132:135]
s_waitcnt lgkmcnt(3)
v_cvt_pk_bf16_f32 v128, v128, v129
v_cvt_pk_bf16_f32 v129, v130, v131
v_mfma_f32_16x16x32_bf16 v[132:135], v[248:251], v[52:55], v[132:135]
ds_write_b32 v9, v128 offset:3072
v_mfma_f32_16x16x32_bf16 v[172:175], a[116:119], v[68:71], v[172:175]
ds_write_b32 v9, v129 offset:3076
v_mfma_f32_16x16x32_bf16 v[172:175], a[128:131], v[72:75], v[172:175]
buffer_store_dwordx4 v[152:155], v13, s[20:23], s51 offen offset:0 sc1
v_mfma_f32_16x16x32_bf16 v[172:175], a[140:143], v[76:79], v[172:175]
ds_read_b128 v[152:155], v12 offset:2048
v_mfma_f32_16x16x32_bf16 v[172:175], a[152:155], v[32:35], v[172:175]
v_mfma_f32_16x16x32_bf16 v[172:175], a[164:167], v[36:39], v[172:175]
v_mfma_f32_16x16x32_bf16 v[172:175], a[176:179], v[40:43], v[172:175]
v_mfma_f32_16x16x32_bf16 v[172:175], a[188:191], v[44:47], v[172:175]
v_mfma_f32_16x16x32_bf16 v[172:175], a[200:203], v[48:51], v[172:175]
v_cvt_pk_bf16_f32 v132, v132, v133
v_cvt_pk_bf16_f32 v133, v134, v135
v_mfma_f32_16x16x32_bf16 v[172:175], a[212:215], v[52:55], v[172:175]
ds_write_b32 v10, v132 offset:3072
v_mfma_f32_16x16x32_bf16 v[164:167], a[108:111], v[68:71], v[164:167]
ds_write_b32 v10, v133 offset:3076
v_mfma_f32_16x16x32_bf16 v[164:167], a[120:123], v[72:75], v[164:167]
s_waitcnt lgkmcnt(7)
v_mfma_f32_16x16x32_bf16 v[164:167], a[132:135], v[76:79], v[164:167]
buffer_store_dwordx4 v[156:159], v14, s[20:23], s51 offen offset:1024 sc1
v_mfma_f32_16x16x32_bf16 v[164:167], a[144:147], v[32:35], v[164:167]
v_mfma_f32_16x16x32_bf16 v[164:167], a[156:159], v[36:39], v[164:167]
v_mfma_f32_16x16x32_bf16 v[164:167], a[168:171], v[40:43], v[164:167]
v_mfma_f32_16x16x32_bf16 v[164:167], a[180:183], v[44:47], v[164:167]
v_mfma_f32_16x16x32_bf16 v[164:167], a[192:195], v[48:51], v[164:167]
v_mfma_f32_16x16x32_bf16 v[164:167], a[204:207], v[52:55], v[164:167]
v_mfma_f32_16x16x32_bf16 v[168:171], a[112:115], v[68:71], v[168:171]
ds_read_b128 v[68:71], v2 offset:41472
v_mfma_f32_16x16x32_bf16 v[168:171], a[124:127], v[72:75], v[168:171]
ds_read_b128 v[72:75], v2 offset:41536
v_mfma_f32_16x16x32_bf16 v[168:171], a[136:139], v[76:79], v[168:171]
ds_read_b128 v[76:79], v2 offset:41600
v_mfma_f32_16x16x32_bf16 v[168:171], a[148:151], v[32:35], v[168:171]
ds_read_b128 v[32:35], v3 offset:41472
v_mfma_f32_16x16x32_bf16 v[168:171], a[160:163], v[36:39], v[168:171]
ds_read_b128 v[36:39], v3 offset:41536
v_mfma_f32_16x16x32_bf16 v[168:171], a[172:175], v[40:43], v[168:171]
ds_read_b128 v[40:43], v3 offset:41600
v_mfma_f32_16x16x32_bf16 v[168:171], a[184:187], v[44:47], v[168:171]
ds_read_b128 v[44:47], v1 offset:25344
v_mfma_f32_16x16x32_bf16 v[168:171], a[196:199], v[48:51], v[168:171]
ds_read_b128 v[48:51], v1 offset:25408
v_mfma_f32_16x16x32_bf16 v[168:171], a[208:211], v[52:55], v[168:171]
ds_read_b128 v[52:55], v1 offset:25472
v_mfma_f32_16x16x32_bf16 v[172:175], a[224:227], v[56:59], v[172:175]
s_waitcnt lgkmcnt(11)
v_mfma_f32_16x16x32_bf16 v[172:175], a[236:239], v[60:63], v[172:175]
buffer_store_dwordx4 v[152:155], v15, s[20:23], s51 offen offset:2048 sc1
v_mfma_f32_16x16x32_bf16 v[172:175], a[248:251], v[64:67], v[172:175]
s_waitcnt lgkmcnt(3)
s_add_u32 s51, s51, 3072
v_mfma_f32_16x16x32_bf16 v[172:175], v[192:195], v[68:71], v[172:175]
v_mfma_f32_16x16x32_bf16 v[172:175], v[204:207], v[72:75], v[172:175]
v_mfma_f32_16x16x32_bf16 v[172:175], v[216:219], v[76:79], v[172:175]
v_mfma_f32_16x16x32_bf16 v[172:175], v[228:231], v[32:35], v[172:175]
v_mfma_f32_16x16x32_bf16 v[172:175], v[240:243], v[36:39], v[172:175]
v_mfma_f32_16x16x32_bf16 v[172:175], v[252:255], v[40:43], v[172:175]
v_mfma_f32_16x16x32_bf16 v[164:167], a[216:219], v[56:59], v[164:167]
v_mfma_f32_16x16x32_bf16 v[164:167], a[228:231], v[60:63], v[164:167]
v_mfma_f32_16x16x32_bf16 v[164:167], a[240:243], v[64:67], v[164:167]
v_mfma_f32_16x16x32_bf16 v[164:167], a[252:255], v[68:71], v[164:167]
v_mfma_f32_16x16x32_bf16 v[164:167], v[196:199], v[72:75], v[164:167]
v_mfma_f32_16x16x32_bf16 v[164:167], v[208:211], v[76:79], v[164:167]
v_mfma_f32_16x16x32_bf16 v[164:167], v[220:223], v[32:35], v[164:167]
v_mfma_f32_16x16x32_bf16 v[164:167], v[232:235], v[36:39], v[164:167]
v_cvt_pk_bf16_f32 v172, v172, v173
v_cvt_pk_bf16_f32 v173, v174, v175
v_mfma_f32_16x16x32_bf16 v[164:167], v[244:247], v[40:43], v[164:167]
ds_write_b32 v11, v172 offset:60672
v_mfma_f32_16x16x32_bf16 v[168:171], a[220:223], v[56:59], v[168:171]
ds_read_b128 v[56:59], v2 offset:25344
v_mfma_f32_16x16x32_bf16 v[168:171], a[232:235], v[60:63], v[168:171]
ds_read_b128 v[60:63], v2 offset:25408
v_mfma_f32_16x16x32_bf16 v[168:171], a[244:247], v[64:67], v[168:171]
ds_read_b128 v[64:67], v2 offset:25472
v_mfma_f32_16x16x32_bf16 v[168:171], v[188:191], v[68:71], v[168:171]
ds_read_b128 v[68:71], v3 offset:25344
v_mfma_f32_16x16x32_bf16 v[168:171], v[200:203], v[72:75], v[168:171]
ds_write_b32 v11, v173 offset:60676
v_mfma_f32_16x16x32_bf16 v[168:171], v[212:215], v[76:79], v[168:171]
ds_read_b128 v[72:75], v3 offset:25408
v_mfma_f32_16x16x32_bf16 v[168:171], v[224:227], v[32:35], v[168:171]
ds_read_b128 v[76:79], v3 offset:25472
v_mfma_f32_16x16x32_bf16 v[168:171], v[236:239], v[36:39], v[168:171]
ds_read_b128 v[32:35], v1 offset:44544
v_cvt_pk_bf16_f32 v164, v164, v165
v_mfma_f32_16x16x32_bf16 v[168:171], v[248:251], v[40:43], v[168:171]
ds_read_b128 v[36:39], v1 offset:44608
s_waitcnt lgkmcnt(6)
v_mfma_f32_16x16x32_bf16 v[148:151], a[224:227], v[44:47], v[148:151]
ds_read_b128 v[40:43], v1 offset:44672
v_cvt_pk_bf16_f32 v165, v166, v167
v_mfma_f32_16x16x32_bf16 v[148:151], a[236:239], v[48:51], v[148:151]
ds_write_b32 v9, v164 offset:60672
v_mfma_f32_16x16x32_bf16 v[148:151], a[248:251], v[52:55], v[148:151]
ds_write_b32 v9, v165 offset:60676
v_mfma_f32_16x16x32_bf16 v[148:151], v[192:195], v[56:59], v[148:151]
v_mfma_f32_16x16x32_bf16 v[148:151], v[204:207], v[60:63], v[148:151]
v_mfma_f32_16x16x32_bf16 v[148:151], v[216:219], v[64:67], v[148:151]
s_waitcnt lgkmcnt(3)
v_mfma_f32_16x16x32_bf16 v[148:151], v[228:231], v[68:71], v[148:151]
v_mfma_f32_16x16x32_bf16 v[148:151], v[240:243], v[72:75], v[148:151]
v_cvt_pk_bf16_f32 v168, v168, v169
v_cvt_pk_bf16_f32 v169, v170, v171
Lstub17:
s_cbranch_execz Lwarmdone
v_mfma_f32_16x16x32_bf16 v[148:151], v[252:255], v[76:79], v[148:151]
ds_write_b32 v10, v168 offset:60672
v_mfma_f32_16x16x32_bf16 v[140:143], a[216:219], v[44:47], v[140:143]
ds_write_b32 v10, v169 offset:60676
v_mfma_f32_16x16x32_bf16 v[140:143], a[228:231], v[48:51], v[140:143]
v_mfma_f32_16x16x32_bf16 v[140:143], a[240:243], v[52:55], v[140:143]
v_mfma_f32_16x16x32_bf16 v[140:143], a[252:255], v[56:59], v[140:143]
v_mfma_f32_16x16x32_bf16 v[140:143], v[196:199], v[60:63], v[140:143]
v_mfma_f32_16x16x32_bf16 v[140:143], v[208:211], v[64:67], v[140:143]
v_mfma_f32_16x16x32_bf16 v[140:143], v[220:223], v[68:71], v[140:143]
v_mfma_f32_16x16x32_bf16 v[140:143], v[232:235], v[72:75], v[140:143]
s_waitcnt lgkmcnt(0)
s_barrier
v_mfma_f32_16x16x32_bf16 v[140:143], v[244:247], v[76:79], v[140:143]
ds_read_b128 v[152:155], v12 offset:3072
v_cvt_pk_bf16_f32 v148, v148, v149
v_mfma_f32_16x16x32_bf16 v[144:147], a[220:223], v[44:47], v[144:147]
ds_read_b128 v[156:159], v12 offset:4096
v_cvt_pk_bf16_f32 v149, v150, v151
v_mfma_f32_16x16x32_bf16 v[144:147], a[232:235], v[48:51], v[144:147]
ds_write_b32 v11, v148 offset:6144
v_mfma_f32_16x16x32_bf16 v[144:147], a[244:247], v[52:55], v[144:147]
ds_write_b32 v11, v149 offset:6148
v_mfma_f32_16x16x32_bf16 v[144:147], v[188:191], v[56:59], v[144:147]
v_mfma_f32_16x16x32_bf16 v[144:147], v[200:203], v[60:63], v[144:147]
v_mfma_f32_16x16x32_bf16 v[144:147], v[212:215], v[64:67], v[144:147]
v_mfma_f32_16x16x32_bf16 v[144:147], v[224:227], v[68:71], v[144:147]
v_mfma_f32_16x16x32_bf16 v[144:147], v[236:239], v[72:75], v[144:147]
s_waitcnt lgkmcnt(3)
v_cvt_pk_bf16_f32 v140, v140, v141
v_cvt_pk_bf16_f32 v141, v142, v143
v_mfma_f32_16x16x32_bf16 v[144:147], v[248:251], v[76:79], v[144:147]
ds_write_b32 v9, v140 offset:6144
v_mfma_f32_16x16x32_bf16 v[184:187], a[116:119], v[44:47], v[184:187]
ds_write_b32 v9, v141 offset:6148
v_mfma_f32_16x16x32_bf16 v[184:187], a[128:131], v[48:51], v[184:187]
buffer_store_dwordx4 v[152:155], v13, s[20:23], s51 offen offset:0 sc1
v_mfma_f32_16x16x32_bf16 v[184:187], a[140:143], v[52:55], v[184:187]
ds_read_b128 v[152:155], v12 offset:5120
v_add_u32 v12, s33, v12
v_mfma_f32_16x16x32_bf16 v[184:187], a[152:155], v[56:59], v[184:187]
v_mfma_f32_16x16x32_bf16 v[184:187], a[164:167], v[60:63], v[184:187]
v_mfma_f32_16x16x32_bf16 v[184:187], a[176:179], v[64:67], v[184:187]
v_mfma_f32_16x16x32_bf16 v[184:187], a[188:191], v[68:71], v[184:187]
v_mfma_f32_16x16x32_bf16 v[184:187], a[200:203], v[72:75], v[184:187]
v_cvt_pk_bf16_f32 v144, v144, v145
v_cvt_pk_bf16_f32 v145, v146, v147
v_mfma_f32_16x16x32_bf16 v[184:187], a[212:215], v[76:79], v[184:187]
ds_write_b32 v10, v144 offset:6144
v_mfma_f32_16x16x32_bf16 v[176:179], a[108:111], v[44:47], v[176:179]
ds_write_b32 v10, v145 offset:6148
v_mfma_f32_16x16x32_bf16 v[176:179], a[120:123], v[48:51], v[176:179]
s_waitcnt lgkmcnt(7)
v_mfma_f32_16x16x32_bf16 v[176:179], a[132:135], v[52:55], v[176:179]
buffer_store_dwordx4 v[156:159], v14, s[20:23], s51 offen offset:1024 sc1
v_mfma_f32_16x16x32_bf16 v[176:179], a[144:147], v[56:59], v[176:179]
v_mfma_f32_16x16x32_bf16 v[176:179], a[156:159], v[60:63], v[176:179]
v_mfma_f32_16x16x32_bf16 v[176:179], a[168:171], v[64:67], v[176:179]
v_mfma_f32_16x16x32_bf16 v[176:179], a[180:183], v[68:71], v[176:179]
v_mfma_f32_16x16x32_bf16 v[176:179], a[192:195], v[72:75], v[176:179]
s_waitcnt lgkmcnt(0)
s_barrier
v_mfma_f32_16x16x32_bf16 v[176:179], a[204:207], v[76:79], v[176:179]
ds_read_b128 v[156:159], v12 offset:0
v_mfma_f32_16x16x32_bf16 v[180:183], a[112:115], v[44:47], v[180:183]
ds_read_b128 v[44:47], v2 offset:44544
v_mfma_f32_16x16x32_bf16 v[180:183], a[124:127], v[48:51], v[180:183]
ds_read_b128 v[48:51], v2 offset:44608
v_mfma_f32_16x16x32_bf16 v[180:183], a[136:139], v[52:55], v[180:183]
ds_read_b128 v[52:55], v2 offset:44672
v_mfma_f32_16x16x32_bf16 v[180:183], a[148:151], v[56:59], v[180:183]
ds_read_b128 v[56:59], v3 offset:44544
v_mfma_f32_16x16x32_bf16 v[180:183], a[160:163], v[60:63], v[180:183]
ds_read_b128 v[60:63], v3 offset:44608
v_mfma_f32_16x16x32_bf16 v[180:183], a[172:175], v[64:67], v[180:183]
ds_read_b128 v[64:67], v3 offset:44672
v_mfma_f32_16x16x32_bf16 v[180:183], a[184:187], v[68:71], v[180:183]
buffer_store_dwordx4 v[152:155], v15, s[20:23], s51 offen offset:2048 sc1
v_mfma_f32_16x16x32_bf16 v[180:183], a[196:199], v[72:75], v[180:183]
ds_read_b128 v[152:155], v12 offset:1024
v_add_u32 v13, s59, v13
v_mfma_f32_16x16x32_bf16 v[180:183], a[208:211], v[76:79], v[180:183]
v_add_u32 v16, s48, v16
v_mfma_f32_16x16x32_bf16 v[184:187], a[224:227], v[32:35], v[184:187]
v_mfma_f32_16x16x32_bf16 v[184:187], a[236:239], v[36:39], v[184:187]
v_mfma_f32_16x16x32_bf16 v[184:187], a[248:251], v[40:43], v[184:187]
s_waitcnt lgkmcnt(1)
v_mfma_f32_16x16x32_bf16 v[184:187], v[192:195], v[44:47], v[184:187]
v_mfma_f32_16x16x32_bf16 v[184:187], v[204:207], v[48:51], v[184:187]
v_mfma_f32_16x16x32_bf16 v[184:187], v[216:219], v[52:55], v[184:187]
buffer_store_dwordx4 v[156:159], v13, s[20:23], s57 offen offset:0 sc1
v_mfma_f32_16x16x32_bf16 v[184:187], v[228:231], v[56:59], v[184:187]
v_mfma_f32_16x16x32_bf16 v[184:187], v[240:243], v[60:63], v[184:187]
v_mfma_f32_16x16x32_bf16 v[184:187], v[252:255], v[64:67], v[184:187]
v_mfma_f32_16x16x32_bf16 v[176:179], a[216:219], v[32:35], v[176:179]
v_mfma_f32_16x16x32_bf16 v[176:179], a[228:231], v[36:39], v[176:179]
v_mfma_f32_16x16x32_bf16 v[176:179], a[240:243], v[40:43], v[176:179]
v_mfma_f32_16x16x32_bf16 v[176:179], a[252:255], v[44:47], v[176:179]
v_mfma_f32_16x16x32_bf16 v[176:179], v[196:199], v[48:51], v[176:179]
s_waitcnt lgkmcnt(0)
v_mfma_f32_16x16x32_bf16 v[176:179], v[208:211], v[52:55], v[176:179]
buffer_store_dwordx4 v[152:155], v16, s[20:23], s57 offen offset:0 sc1
v_mfma_f32_16x16x32_bf16 v[176:179], v[220:223], v[56:59], v[176:179]
s_add_u32 s57, s57, s41
v_mfma_f32_16x16x32_bf16 v[176:179], v[232:235], v[60:63], v[176:179]
v_cvt_pk_bf16_f32 v184, v184, v185
v_cvt_pk_bf16_f32 v185, v186, v187
v_mfma_f32_16x16x32_bf16 v[176:179], v[244:247], v[64:67], v[176:179]
ds_write_b64 v11, v[184:185] offset:63744
v_mfma_f32_16x16x32_bf16 v[180:183], a[220:223], v[32:35], v[180:183]
v_mfma_f32_16x16x32_bf16 v[180:183], a[232:235], v[36:39], v[180:183]
v_mfma_f32_16x16x32_bf16 v[180:183], a[244:247], v[40:43], v[180:183]
s_waitcnt lgkmcnt(0)
s_barrier
v_mfma_f32_16x16x32_bf16 v[180:183], v[188:191], v[44:47], v[180:183]
ds_read_b128 v[152:155], v4
v_mfma_f32_16x16x32_bf16 v[180:183], v[200:203], v[48:51], v[180:183]
v_mfma_f32_16x16x32_bf16 v[180:183], v[212:215], v[52:55], v[180:183]
v_mfma_f32_16x16x32_bf16 v[180:183], v[224:227], v[56:59], v[180:183]
v_mfma_f32_16x16x32_bf16 v[180:183], v[236:239], v[60:63], v[180:183]
v_cvt_pk_bf16_f32 v176, v176, v177
v_cvt_pk_bf16_f32 v177, v178, v179
v_mfma_f32_16x16x32_bf16 v[180:183], v[248:251], v[64:67], v[180:183]
s_waitcnt lgkmcnt(0)
buffer_store_dwordx4 v[152:155], v5, s[20:23], s57 offen sc1
s_nop 5
v_cvt_pk_bf16_f32 v178, v180, v181
v_cvt_pk_bf16_f32 v179, v182, v183
s_nop 1
v_permlane16_swap_b32 v176, v178
v_permlane16_swap_b32 v177, v179
buffer_store_dwordx4 v[176:179], v17, s[20:23], s57 offen sc1
Lend:
s_endpgm
s_nop 0
s_nop 0
s_nop 0
s_nop 0
s_nop 0
s_nop 0
s_nop 0
s_nop 0
s_nop 0
s_nop 0
s_nop 0
s_nop 0
s_nop 0
s_nop 0
s_nop 0
s_nop 0
s_nop 0
s_nop 0
s_nop 0
s_nop 0
s_nop 0
s_nop 0
s_nop 0
s_nop 0
s_nop 0
s_nop 0
s_nop 0
s_nop 0
s_nop 0
s_nop 0
s_nop 0
s_nop 0
s_nop 0
s_nop 0
s_nop 0
s_nop 0
s_nop 0
s_nop 0
s_nop 0
s_nop 0
s_nop 0
s_nop 0
s_nop 0
s_nop 0
s_nop 0
s_nop 0
s_nop 0
s_nop 0
s_nop 0
s_nop 0
s_nop 0
s_nop 0
s_nop 0
s_nop 0
s_nop 0
s_nop 0
s_nop 0
s_nop 0
s_nop 0
s_nop 0
s_nop 0
s_nop 0
s_nop 0
s_nop 0
.section .rodata,"a"
.p2align 6
.amdhsa_kernel standalone__standard_2d_1d_3d_conv__vision_kernel
  .amdhsa_next_free_vgpr 512
  .amdhsa_next_free_sgpr 102
  .amdhsa_accum_offset 256
  .amdhsa_group_segment_fixed_size 0
  .amdhsa_kernarg_size 48
  .amdhsa_user_sgpr_count 2
  .amdhsa_user_sgpr_kernarg_segment_ptr 1
  .amdhsa_system_sgpr_workgroup_id_x 1
.end_amdhsa_kernel
```
